```python
import torch

def _softmax(x, axis=-1):
    return torch.softmax(x, dim=axis)
def _gelu(x):
    return torch.nn.functional.gelu(x, approximate="tanh")
def _silu(x):
    return torch.nn.functional.silu(x)
def _sigmoid(x):
    return torch.sigmoid(x)
def _layernorm(x, axis=-1, eps=1e-5):
    m = x.mean(dim=axis, keepdim=True)
    v = x.var(dim=axis, keepdim=True, unbiased=False)
    return (x - m) / torch.sqrt(v + eps)
def _scatter_add(tgt, idx, src, axis=0):
    return tgt.clone().index_add_(axis, idx, src)
def _segment_sum(src, seg, n):
    out = torch.zeros((n,) + src.shape[1:], dtype=src.dtype)
    return out.index_add_(0, seg, src)
def _pad(x, pw):
    flat = tuple(v for pair in reversed(pw) for v in pair)
    return torch.nn.functional.pad(x, flat)

kernel_name = 'sequential_preLN__ssm_conv_s4d__geglu_ffn__prompt'

def setup_inputs():

    _w = (lambda a: (lambda t: t.to(torch.bfloat16) if t.is_floating_point() else t)(torch.as_tensor(a)))
    def _A_setup():
        Bsz, L, D, N = 1, 2048, 512, 128
        return {
            "u": _w((lambda *s: torch.randn(*s, dtype=torch.bfloat16) * 0.05)(Bsz, L, D)),
            "log_A_real": _w((lambda *s: torch.randn(*s, dtype=torch.bfloat16) * 6.4)(D, N) * 0.5),
            "A_imag": _w((lambda *s: torch.randn(*s, dtype=torch.bfloat16) * 0.05)(D, N) * 3.14),
            "C_real": _w((lambda *s: torch.randn(*s, dtype=torch.bfloat16) * 0.05)(D, N) / N ** 0.5),
            "C_imag": _w((lambda *s: torch.randn(*s, dtype=torch.bfloat16) * 0.05)(D, N) / N ** 0.5),
            "log_dt": _w((lambda *s: torch.randn(*s, dtype=torch.bfloat16) * 0.05)(D) * 0.5 - 4.0),
            "D_skip": _w((lambda *s: torch.randn(*s, dtype=torch.bfloat16) * 0.05)(D)),
        }
    _A_in = _A_setup()

    def _B_setup():
        B, S, D, F = 1, 2048, 512, 1376
        return {
            "x": _w((lambda *s: torch.randn(*s, dtype=torch.bfloat16) * 0.05)(B, S, D)),
            "w_gate": _w((lambda *s: torch.randn(*s, dtype=torch.bfloat16) * 0.05)(D, F)),
            "w_up": _w((lambda *s: torch.randn(*s, dtype=torch.bfloat16) * 0.05)(D, F)),
            "w_down": _w((lambda *s: torch.randn(*s, dtype=torch.bfloat16) * 0.05)(F, D)),
        }
    _B_in = _B_setup()

    return {
        "A_u": _A_in["u"],
        "A_log_A_real": _A_in["log_A_real"],
        "A_A_imag": _A_in["A_imag"],
        "A_C_real": _A_in["C_real"],
        "A_C_imag": _A_in["C_imag"],
        "A_log_dt": _A_in["log_dt"],
        "A_D_skip": _A_in["D_skip"],
        "B_x": _B_in["x"],
        "B_w_gate": _B_in["w_gate"],
        "B_w_up": _B_in["w_up"],
        "B_w_down": _B_in["w_down"],
    }

def reference(A_u, A_log_A_real, A_A_imag, A_C_real, A_C_imag, A_log_dt, A_D_skip, B_x, B_w_gate, B_w_up, B_w_down):
    def _A_ref(u, log_A_real, A_imag, C_real, C_imag, log_dt, D_skip):
        L = u.shape[1]
        dt = torch.exp(log_dt)
        A = -torch.exp(log_A_real) + 1j * A_imag
        C = (C_real + 1j * C_imag) * dt[:, None]
        pos = (lambda x, dt: x.to(dt))(torch.arange(L), log_dt.dtype)
        P = torch.exp((A * dt[:, None])[:, :, None] * pos[None, None, :])
        K = 2.0 * torch.einsum("dn,dnl->dl", C, P).real
        L2 = 2 * L
        u_t = (lambda x, *d: x.permute(*d))(u, 0, 2, 1)
        Kf = (lambda x, *a, **k: torch.fft.rfft(x.float(), *a, **k))(K, L2)
        Uf = (lambda x, *a, **k: torch.fft.rfft(x.float(), *a, **k))(u_t, L2)
        y = (lambda x, *a, **k: torch.fft.irfft(x, *a, **k).to(torch.bfloat16))(Uf * Kf[None, :, :], L2)[:, :, :L]
        y = (lambda x, *d: x.permute(*d))(y, 0, 2, 1)
        return y + u * D_skip[None, None, :]

    def _B_ref(x, w_gate, w_up, w_down):
        return (_gelu(x @ w_gate) * (x @ w_up)) @ w_down

    x = A_u
    h = x + _A_ref(_layernorm(x, axis=-1), A_log_A_real, A_A_imag, A_C_real, A_C_imag, A_log_dt, A_D_skip)
    h2 = h + _B_ref(_layernorm(h, axis=-1), B_w_gate, B_w_up, B_w_down)
    return h2
```

```asm
; @launch grid=(256,1,1) block=(256,1,1) lds=163840
.amdgcn_target "amdgcn-amd-amdhsa--gfx950"

.text
.p2align 12
.text
.globl sequential_preLN__ssm_conv_s4d__geglu_ffn__prompt_kernel
.p2align 8
.type sequential_preLN__ssm_conv_s4d__geglu_ffn__prompt_kernel,@function
sequential_preLN__ssm_conv_s4d__geglu_ffn__prompt_kernel:
K_body:
    s_cmp_ge_u32 s2, 256
    s_cbranch_scc1 K_end
    s_load_dwordx16 s[16:31], s[0:1], 0
    s_load_dwordx8 s[32:39], s[0:1], 64
    s_load_dwordx2 s[42:43], s[0:1], 104
    v_lshrrev_b32 v2, 6, v0
    v_and_b32 v1, 63, v0
    v_readfirstlane_b32 s3, v2
    s_and_b32 s47, s2, 7
    s_lshr_b32 s48, s2, 3
    s_getpc_b64 s[14:15]
K_pc:
    s_lshl_b32 s4, s48, 11
    v_lshl_add_u32 v9, v0, 7, s4
    v_min_u32 v9, K_last-K_pc-4, v9
    v_cmp_gt_u32 vcc, 16, v0
    s_nop 0
    s_and_saveexec_b64 s[12:13], vcc
    s_cbranch_execz K_nopf
    global_load_dword v255, v9, s[14:15]
K_nopf:
    s_mov_b64 exec, s[12:13]
    s_lshl_b32 s51, s47, 5
    s_add_u32 s51, s51, s48
    s_lshl_b32 s4, s2, 13
    s_lshl_b32 s57, s3, 11
    s_add_u32 s4, s4, s57
    v_lshl_add_u32 v2, v1, 4, s4
    s_lshr_b32 s49, s3, 1
    s_and_b32 s50, s3, 1
    s_lshl_b32 s4, s51, 9
    s_lshl_b32 s5, s49, 8
    s_add_u32 s4, s4, s5
    v_lshl_add_u32 v6, v1, 2, s4
    s_lshl_b32 s5, s51, 2
    s_waitcnt lgkmcnt(0)
    global_load_dwordx4 v[8:11], v2, s[16:17] nt
    global_load_dwordx4 v[12:15], v2, s[16:17] offset:1024 nt
    s_load_dword s44, s[42:43], 0
    s_load_dword s45, s[26:27], s5
    s_load_dword s46, s[28:29], s5
    v_and_b32 v4, 7, v1
    v_lshl_add_u32 v4, s50, 3, v4
    v_lshrrev_b32 v5, 3, v1
    v_lshl_add_u32 v5, s49, 3, v5
    s_and_b32 s6, s2, 7
    s_lshr_b32 s7, s2, 3
    s_lshl_b32 s4, s7, 16
    s_lshl_b32 s1, s6, 7
    s_add_u32 s4, s4, s1
    v_lshl_add_u32 v3, v4, 12, s4
    v_lshl_add_u32 v3, v5, 3, v3
    global_load_dword v24, v6, s[18:19] nt
    global_load_dword v25, v6, s[20:21] nt
    global_load_dword v26, v6, s[22:23] nt
    global_load_dword v27, v6, s[24:25] nt
    s_lshl_b32 s4, s2, 6
    s_lshl_b32 s5, s3, 4
    s_add_u32 s4, s4, s5
    s_add_u32 s4, s4, 16384
    v_mov_b32 v190, s4
    global_load_dwordx2 v[116:117], v3, s[16:17] offset:0 nt
    global_load_dwordx2 v[118:119], v3, s[16:17] offset:1024 nt
    global_load_dwordx2 v[120:121], v3, s[16:17] offset:2048 nt
    global_load_dwordx2 v[122:123], v3, s[16:17] offset:3072 nt
    s_bfe_u32 s4, s48, 0x20003
    s_lshl_b32 s4, s4, 6
    s_lshl_b32 s5, s47, 3
    s_add_u32 s4, s4, s5
    s_and_b32 s5, s48, 7
    s_add_u32 s4, s4, s5
    s_lshl_b32 s4, s4, 4
    s_add_u32 s4, s4, 524288
    v_and_b32 v128, 15, v1
    v_lshl_add_u32 v191, v128, 15, s4
    v_lshrrev_b32 v128, 2, v1
    v_cmp_eq_u32 vcc, s3, v128
    s_nop 1
    v_cndmask_b32 v128, v190, v191, vcc
    global_load_dword v253, v128, s[42:43]
    s_lshl_b32 s4, s6, 18
    s_lshl_b32 s5, s7, 8
    s_add_u32 s4, s4, s5
    s_add_u32 s4, s4, 1048576
    v_lshl_add_u32 v112, v4, 4, s4
    v_lshl_add_u32 v112, v5, 14, v112
    v_add_u32 v113, 0x2000, v112
    s_lshl_b32 s4, s6, 16
    s_lshl_b32 s5, s7, 11
    s_add_u32 s4, s4, s5
    s_add_u32 s4, s4, 3145728
    v_lshl_add_u32 v114, v0, 3, s4
    v_and_b32 v4, 15, v1
    v_lshrrev_b32 v5, 4, v1
    s_mul_i32 s4, s3, 17408
    s_add_u32 s4, s4, 65536
    v_lshl_add_u32 v168, v1, 3, s4
    s_cmp_eq_u32 s49, 0
    s_cselect_b32 s12, s32, s34
    s_cselect_b32 s13, s33, s35
    s_mov_b32 s15, 0x20000
    s_lshl_b32 s4, s47, 7
    s_add_u32 s4, s4, 204800
    v_and_b32 v128, 31, v1
    v_lshl_add_u32 v193, v128, 2, s4
    s_mul_i32 s6, s2, 5504
    s_mul_i32 s4, s50, 1408
    s_add_u32 s4, s6, s4
    v_min_u32 v128, 10, v1
    v_lshl_add_u32 v194, v128, 7, s4
    s_mul_i32 s4, s3, 1408
    s_add_u32 s4, s6, s4
    v_lshl_add_u32 v167, v128, 7, s4
    s_lshl_b32 s4, s47, 16
    s_lshr_b32 s5, s48, 4
    s_lshl_b32 s5, s5, 10
    s_add_u32 s4, s4, s5
    s_bfe_u32 s5, s48, 0x30001
    s_lshl_b32 s5, s5, 6
    s_add_u32 s4, s4, s5
    s_and_b32 s5, s48, 1
    s_lshl_b32 s5, s5, 2
    s_add_u32 s4, s4, s5
    s_add_u32 s4, s4, 3145728
    v_and_b32 v128, 7, v0
    v_lshl_add_u32 v128, v128, 3, s4
    v_bfe_u32 v129, v0, 3, 1
    v_lshl_add_u32 v128, v129, 9, v128
    v_lshrrev_b32 v129, 4, v0
    v_lshl_add_u32 v178, v129, 11, v128
    v_add_u32 v179, 0x8000, v178
    v_lshlrev_b32 v181, 4, v0
    v_lshlrev_b32 v128, 5, v0
    v_add_u32 v175, 16384, v128
    v_add_u32 v176, 24576, v128
    s_lshl_b32 s4, s51, 13
    s_add_u32 s4, s4, 1050624
    v_add_u32 v177, s4, v181
    v_mov_b32 v132, 0
    v_mov_b32 v133, 0
    v_mov_b32 v134, 0
    v_mov_b32 v135, 0
    v_and_b32 v130, 31, v1
    v_lshrrev_b32 v128, 5, v1
    v_mul_u32_u24 v128, 4608, v128
    v_lshl_add_u32 v128, v130, 4, v128
    v_add_u32 v128, 33280, v128
    v_bfe_u32 v129, v1, 1, 3
    v_mul_u32_u24 v129, 4160, v129
    v_and_b32 v130, 1, v1
    v_lshl_add_u32 v129, v130, 4, v129
    v_add_u32 v129, 4096, v129
    v_cmp_gt_u32 vcc, 64, v0
    s_nop 1
    v_cndmask_b32 v128, v129, v128, vcc
    ds_write_b128 v128, v[132:135]
    v_mul_u32_u24 v128, 544, v4
    v_lshl_add_u32 v128, v5, 4, v128
    s_mul_i32 s4, s49, 34816
    s_add_u32 s4, s4, 65536
    v_add_u32 v170, s4, v128
    s_mul_i32 s5, s50, 8704
    s_add_u32 s5, s5, 17408
    v_add_u32 v169, s5, v170
    v_cmp_gt_u32 vcc, 32, v1
    s_mul_i32 s4, s49, 16640
    s_add_u32 s4, s4, 0
    s_cmp_eq_u32 s50, 0
    s_cbranch_scc0 A_pre1
    v_mov_b32 v128, 0x03020504
    v_mov_b32 v129, 0x05040706
    v_cndmask_b32 v171, v128, v129, vcc
    v_mov_b32 v128, 0x01000100
    v_mov_b32 v129, 0x01000302
    v_cndmask_b32 v172, v128, v129, vcc
    v_lshlrev_b32 v128, 4, v4
    v_and_b32 v129, 1, v5
    v_lshl_add_u32 v128, v129, 3, v128
    v_lshrrev_b32 v129, 1, v5
    v_lshl_add_u32 v128, v129, 9, v128
    s_add_u32 s5, s4, 3832
    s_branch A_pre_done
A_pre1:
    v_mov_b32 v128, 0x03020302
    v_mov_b32 v129, 0x05040504
    v_cndmask_b32 v171, v128, v129, vcc
    v_and_b32 v129, 1, v1
    v_mul_u32_u24 v129, 0x0202, v129
    v_lshlrev_b32 v129, 16, v129
    v_add_u32 v129, 0x01000302, v129
    v_cndmask_b32 v172, v129, v128, vcc
    v_mov_b32 v128, 0x01000100
    v_mov_b32 v129, 0x01000302
    v_cndmask_b32 v173, v128, v129, vcc
    v_lshlrev_b32 v128, 9, v5
    v_lshlrev_b32 v129, 10, v5
    v_subrev_u32 v129, 1024, v129
    v_cndmask_b32 v128, v129, v128, vcc
    v_lshl_add_u32 v128, v4, 4, v128
    s_add_u32 s5, s4, 2288
A_pre_done:
    v_sub_u32 v174, s5, v128
    s_lshl_b32 s7, s49, 8
    v_sub_u32 v128, 3, v4
    v_and_b32 v128, 3, v128
    v_mul_u32_u24 v128, 4160, v128
    v_lshrrev_b32 v129, 2, v4
    v_lshlrev_b32 v129, 3, v129
    v_sub_u32 v128, v128, v129
    v_lshl_add_u32 v128, v5, 4, v128
    s_sub_u32 s4, 280, s7
    v_add_u32 v6, s4, v128
    s_mov_b32 s16, s36
    s_mov_b32 s17, s37
    s_mov_b32 s18, 1409024
    s_mov_b32 s19, 0x20000
    s_lshr_b32 s53, s48, 4
    s_lshl_b32 s4, s47, 1
    s_add_u32 s53, s53, s4
    s_and_b32 s54, s48, 15
    s_add_u32 s61, s47, s54
    v_lshlrev_b32 v163, 4, v1
    s_sub_u32 s6, 7, s50
    s_add_u32 s7, s50, 2
    s_cmp_eq_u32 s49, 0
    s_cselect_b32 s6, s6, s7
    s_sub_u32 s7, s6, 2
    s_lshl_b32 s52, 5, s7
    s_lshl_b32 s7, s49, 8
    v_lshlrev_b32 v128, 5, v4
    v_lshl_add_u32 v129, v5, 4, v128
    s_sub_u32 s4, 33568, s7
    v_add_u32 v7, s4, v129
    v_lshl_add_u32 v128, v5, 3, v128
    s_lshl_b32 s4, s6, 9
    s_add_u32 s5, s4, 32768
    v_add_u32 v186, s5, v128
    s_lshl_b32 s4, s6, 10
    s_add_u32 s4, s4, 40448
    v_lshl_add_u32 v187, v128, 1, s4
    v_and_b32 v128, 7, v4
    v_lshlrev_b32 v128, 1, v128
    v_lshrrev_b32 v129, 1, v5
    v_add_u32 v128, v128, v129
    s_and_b32 s4, s51, 3
    s_lshl_b32 s4, s4, 2
    v_xor_b32 v128, s4, v128
    v_lshlrev_b32 v128, 4, v128
    v_lshrrev_b32 v129, 3, v4
    v_lshl_add_u32 v128, v129, 17, v128
    v_and_b32 v129, 1, v5
    v_lshlrev_b32 v129, 19, v129
    v_sub_u32 v128, v128, v129
    s_lshl_b32 s4, s51, 8
    s_lshl_b32 s6, s6, 18
    s_add_u32 s4, s4, s6
    s_add_u32 s4, s4, 6291456
    v_add_u32 v188, s4, v128
    v_add_u32 v189, 0x10000, v188
    s_add_u32 s4, s57, 42496
    s_xor_b32 s5, s57, 4096
    s_add_u32 s5, s5, 42496
    v_add_u32 v195, s4, v163
    v_add_u32 v2, s5, v163
    v_lshlrev_b32 v128, 3, v0
    v_add_u32 v184, 33792, v128
    s_cmp_eq_u32 s54, 15
    s_cselect_b32 s14, 0, 1409024
    s_cmp_eq_u32 s54, 14
    s_cselect_b32 s1, 3, 11
    v_mov_b32 v131, 0x1000000
    s_mul_i32 s4, s50, 192
    s_lshl_b32 s5, s49, 1
    s_mul_i32 s7, s54, 192
    s_add_u32 s6, s4, 0
    v_add_u32 v128, s6, v1
    v_mul_u32_u24 v129, 5462, v128
    v_lshrrev_b32 v129, 16, v129
    v_mul_u32_u24 v130, 12, v129
    v_sub_u32 v128, v128, v130
    v_xor_b32 v128, s5, v128
    v_cmp_lt_u32 vcc, s1, v128
    v_mul_u32_u24 v129, 5504, v129
    v_lshl_add_u32 v129, v128, 4, v129
    v_add_u32 v129, s7, v129
    v_cndmask_b32 v160, v129, v131, vcc
    s_sub_u32 s7, s7, 1024
    s_add_u32 s6, s4, 64
    v_add_u32 v128, s6, v1
    v_mul_u32_u24 v129, 5462, v128
    v_lshrrev_b32 v129, 16, v129
    v_mul_u32_u24 v130, 12, v129
    v_sub_u32 v128, v128, v130
    v_xor_b32 v128, s5, v128
    v_cmp_lt_u32 vcc, s1, v128
    v_mul_u32_u24 v129, 5504, v129
    v_lshl_add_u32 v129, v128, 4, v129
    v_add_u32 v129, s7, v129
    v_cndmask_b32 v161, v129, v131, vcc
    s_sub_u32 s7, s7, 1024
    s_add_u32 s6, s4, 128
    v_add_u32 v128, s6, v1
    v_mul_u32_u24 v129, 5462, v128
    v_lshrrev_b32 v129, 16, v129
    v_mul_u32_u24 v130, 12, v129
    v_sub_u32 v128, v128, v130
    v_xor_b32 v128, s5, v128
    v_cmp_lt_u32 vcc, s1, v128
    v_mul_u32_u24 v129, 5504, v129
    v_lshl_add_u32 v129, v128, 4, v129
    v_add_u32 v129, s7, v129
    v_cndmask_b32 v162, v129, v131, vcc
    s_sub_u32 s7, s7, 1024
    s_mov_b32 s8, s42
    s_mov_b32 s9, s43
    s_mov_b32 s10, 16777216
    s_mov_b32 s11, 0x20000
    s_mul_i32 s58, s49, 49152
    s_mul_i32 s4, s50, 3072
    s_add_u32 s58, s58, s4
    s_add_u32 s58, s58, 65536
    s_mul_i32 s4, s48, 43
    s_mul_i32 s5, s3, 11
    s_add_u32 s4, s4, s5
    s_lshl_b32 s4, s4, 10
    s_add_u32 s4, s4, 384
    v_and_b32 v128, 15, v1
    v_min_u32 v128, 10, v128
    v_lshl_add_u32 v252, v128, 10, s4
    s_waitcnt lgkmcnt(0)
    s_mul_i32 s44, s44, 1664525
    s_add_u32 s44, s44, 1013904223
    s_add_u32 s4, s61, 0
    s_and_b32 s4, s4, 7
    s_mul_i32 s20, s4, 176128
    s_add_u32 s4, s61, 1
    s_and_b32 s4, s4, 7
    s_mul_i32 s21, s4, 176128
    s_add_u32 s4, s61, 2
    s_and_b32 s4, s4, 7
    s_mul_i32 s22, s4, 176128
    s_add_u32 s4, s61, 3
    s_and_b32 s4, s4, 7
    s_mul_i32 s23, s4, 176128
    s_add_u32 s4, s61, 4
    s_and_b32 s4, s4, 7
    s_mul_i32 s24, s4, 176128
    s_add_u32 s4, s61, 5
    s_and_b32 s4, s4, 7
    s_mul_i32 s25, s4, 176128
    s_add_u32 s4, s61, 6
    s_and_b32 s4, s4, 7
    s_mul_i32 s26, s4, 176128
    s_add_u32 s4, s61, 7
    s_and_b32 s4, s4, 7
    s_mul_i32 s27, s4, 176128
    s_lshl_b32 s0, s46, 16
    s_and_b32 s40, s46, 0xffff0000
    v_mov_b32 v63, s44
    s_getreg_b32 s60, hwreg(HW_REG_XCC_ID, 0, 4)
    s_add_u32 s60, s60, s44
    v_mov_b32 v192, s60
    s_lshl_b32 s4, s49, 4
    s_lshr_b32 s45, s45, s4
    s_lshl_b32 s45, s45, 16
    v_mov_b32 v56, 0x3fb8aa3b
    v_mul_f32 v57, s45, v56
    v_exp_f32 v57, v57
    s_nop 0
    v_cvt_pk_bf16_f32 v57, v57, v57
    v_and_b32 v57, 0xffff0000, v57
    s_mov_b64 exec, 0
    s_cmp_eq_u32 s3, 0
    s_cbranch_scc1 PG0
    s_cmp_eq_u32 s3, 1
    s_cbranch_scc1 PG1
    s_cmp_eq_u32 s3, 2
    s_cbranch_scc1 PG2
    s_cmp_eq_u32 s3, 3
    s_cbranch_scc1 PG3
WARM0_0_ret:
    s_mov_b64 exec, -1
    s_mov_b32 s5, 0x3f803f80
    s_waitcnt vmcnt(9)
    v_lshlrev_b32 v64, 16, v8
    v_and_b32 v65, 0xffff0000, v8
    v_lshlrev_b32 v66, 16, v9
    v_and_b32 v67, 0xffff0000, v9
    v_lshlrev_b32 v68, 16, v10
    v_and_b32 v69, 0xffff0000, v10
    v_lshlrev_b32 v70, 16, v11
    v_and_b32 v71, 0xffff0000, v11
    v_lshlrev_b32 v72, 16, v12
    v_and_b32 v73, 0xffff0000, v12
    v_lshlrev_b32 v74, 16, v13
    v_and_b32 v75, 0xffff0000, v13
    v_lshlrev_b32 v76, 16, v14
    v_and_b32 v77, 0xffff0000, v14
    v_lshlrev_b32 v78, 16, v15
    v_and_b32 v79, 0xffff0000, v15
    v_pk_add_f32 v[80:81], v[64:65], v[66:67]
    v_pk_add_f32 v[82:83], v[68:69], v[70:71]
    v_pk_add_f32 v[84:85], v[72:73], v[74:75]
    v_pk_add_f32 v[86:87], v[76:77], v[78:79]
    v_pk_add_f32 v[80:81], v[80:81], v[82:83]
    v_pk_add_f32 v[84:85], v[84:85], v[86:87]
    v_add_f32 v80, v80, v81
    v_add_f32 v84, v84, v85
    s_nop 0
    v_add_f32_dpp v80, v80, v80 quad_perm:[1,0,3,2] row_mask:0xf bank_mask:0xf
    v_add_f32_dpp v84, v84, v84 quad_perm:[1,0,3,2] row_mask:0xf bank_mask:0xf
    s_nop 0
    v_add_f32_dpp v80, v80, v80 quad_perm:[2,3,0,1] row_mask:0xf bank_mask:0xf
    v_add_f32_dpp v84, v84, v84 quad_perm:[2,3,0,1] row_mask:0xf bank_mask:0xf
    s_nop 0
    v_add_f32_dpp v80, v80, v80 row_half_mirror row_mask:0xf bank_mask:0xf
    v_add_f32_dpp v84, v84, v84 row_half_mirror row_mask:0xf bank_mask:0xf
    s_nop 0
    v_add_f32_dpp v80, v80, v80 row_mirror row_mask:0xf bank_mask:0xf
    v_add_f32_dpp v84, v84, v84 row_mirror row_mask:0xf bank_mask:0xf
    s_nop 0
    v_add_f32_dpp v80, v80, v80 row_bcast:15 row_mask:0xa bank_mask:0xf
    v_add_f32_dpp v84, v84, v84 row_bcast:15 row_mask:0xa bank_mask:0xf
    s_nop 0
    v_add_f32_dpp v80, v80, v80 row_bcast:31 row_mask:0xc bank_mask:0xf
    v_add_f32_dpp v84, v84, v84 row_bcast:31 row_mask:0xc bank_mask:0xf
    v_mul_f32 v80, 0x3b000000, v80
    v_mul_f32 v84, 0x3b000000, v84
    v_readlane_b32 s4, v80, 63
    v_readlane_b32 s6, v84, 63
    s_nop 0
    v_pk_add_f32 v[64:65], v[64:65], s[4:5] op_sel_hi:[1,0] neg_lo:[0,1] neg_hi:[0,1]
    v_pk_add_f32 v[66:67], v[66:67], s[4:5] op_sel_hi:[1,0] neg_lo:[0,1] neg_hi:[0,1]
    v_pk_add_f32 v[68:69], v[68:69], s[4:5] op_sel_hi:[1,0] neg_lo:[0,1] neg_hi:[0,1]
    v_pk_add_f32 v[70:71], v[70:71], s[4:5] op_sel_hi:[1,0] neg_lo:[0,1] neg_hi:[0,1]
    v_pk_add_f32 v[72:73], v[72:73], s[6:7] op_sel_hi:[1,0] neg_lo:[0,1] neg_hi:[0,1]
    v_pk_add_f32 v[74:75], v[74:75], s[6:7] op_sel_hi:[1,0] neg_lo:[0,1] neg_hi:[0,1]
    v_pk_add_f32 v[76:77], v[76:77], s[6:7] op_sel_hi:[1,0] neg_lo:[0,1] neg_hi:[0,1]
    v_pk_add_f32 v[78:79], v[78:79], s[6:7] op_sel_hi:[1,0] neg_lo:[0,1] neg_hi:[0,1]
    v_pk_mul_f32 v[82:83], v[64:65], v[64:65]
    v_pk_mul_f32 v[86:87], v[72:73], v[72:73]
    v_pk_fma_f32 v[82:83], v[66:67], v[66:67], v[82:83]
    v_pk_fma_f32 v[86:87], v[74:75], v[74:75], v[86:87]
    v_pk_fma_f32 v[82:83], v[68:69], v[68:69], v[82:83]
    v_pk_fma_f32 v[86:87], v[76:77], v[76:77], v[86:87]
    v_pk_fma_f32 v[82:83], v[70:71], v[70:71], v[82:83]
    v_pk_fma_f32 v[86:87], v[78:79], v[78:79], v[86:87]
    v_add_f32 v82, v82, v83
    v_add_f32 v86, v86, v87
    s_nop 0
    v_add_f32_dpp v82, v82, v82 quad_perm:[1,0,3,2] row_mask:0xf bank_mask:0xf
    v_add_f32_dpp v86, v86, v86 quad_perm:[1,0,3,2] row_mask:0xf bank_mask:0xf
    s_nop 0
    v_add_f32_dpp v82, v82, v82 quad_perm:[2,3,0,1] row_mask:0xf bank_mask:0xf
    v_add_f32_dpp v86, v86, v86 quad_perm:[2,3,0,1] row_mask:0xf bank_mask:0xf
    s_nop 0
    v_add_f32_dpp v82, v82, v82 row_half_mirror row_mask:0xf bank_mask:0xf
    v_add_f32_dpp v86, v86, v86 row_half_mirror row_mask:0xf bank_mask:0xf
    s_nop 0
    v_add_f32_dpp v82, v82, v82 row_mirror row_mask:0xf bank_mask:0xf
    v_add_f32_dpp v86, v86, v86 row_mirror row_mask:0xf bank_mask:0xf
    s_nop 0
    v_add_f32_dpp v82, v82, v82 row_bcast:15 row_mask:0xa bank_mask:0xf
    v_add_f32_dpp v86, v86, v86 row_bcast:15 row_mask:0xa bank_mask:0xf
    s_nop 0
    v_add_f32_dpp v82, v82, v82 row_bcast:31 row_mask:0xc bank_mask:0xf
    v_add_f32_dpp v86, v86, v86 row_bcast:31 row_mask:0xc bank_mask:0xf
    v_mul_f32 v82, 0x3b000000, v82
    v_mul_f32 v86, 0x3b000000, v86
    v_cvt_pk_bf16_f32 v62, -v80, -v84
    v_cvt_pk_bf16_f32 v82, v82, v86
    v_lshlrev_b32 v64, 16, v82
    v_and_b32 v65, 0xffff0000, v82
    v_add_f32 v64, 0x3727c5ac, v64
    v_add_f32 v65, 0x3727c5ac, v65
    v_cvt_pk_bf16_f32 v82, v64, v65
    v_lshlrev_b32 v64, 16, v82
    v_and_b32 v65, 0xffff0000, v82
    v_sqrt_f32 v64, v64
    v_sqrt_f32 v65, v65
    s_nop 0
    v_cvt_pk_bf16_f32 v82, v64, v65
    v_lshlrev_b32 v64, 16, v82
    v_and_b32 v65, 0xffff0000, v82
    v_rcp_f32 v60, v64
    v_rcp_f32 v61, v65
    s_mov_b32 exec_lo, 0
    s_mov_b32 exec_hi, 0x80000000
    global_store_dwordx4 v190, v[60:63], s[42:43] sc1
    s_mov_b64 exec, -1
    s_waitcnt vmcnt(6)
    v_lshlrev_b32 v10, 16, v24
    v_and_b32 v11, 0xffff0000, v24
    v_lshlrev_b32 v12, 16, v25
    v_and_b32 v13, 0xffff0000, v25
    v_mul_f32 v10, v56, v10
    v_mul_f32 v11, v56, v11
    v_exp_f32 v10, v10
    v_exp_f32 v11, v11
    v_mul_f32 v12, v57, v12
    v_mul_f32 v13, v57, v13
    v_cvt_pk_bf16_f32 v14, v10, v11
    v_lshlrev_b32 v10, 16, v14
    v_and_b32 v11, 0xffff0000, v14
    v_mul_f32 v12, 0.15915494, v12
    v_mul_f32 v13, 0.15915494, v13
    v_mul_f32 v10, v57, v10
    v_mul_f32 v11, v57, v11
    v_mul_f32 v10, -v56, v10
    v_mul_f32 v11, -v56, v11
    s_cmp_eq_u32 s50, 0
    s_cbranch_scc0 A_xwave
    s_mov_b32 s4, 0x41000000
    v_mul_f32 v20, s4, v10
    v_mul_f32 v22, s4, v12
    v_mul_f32 v21, s4, v11
    v_mul_f32 v23, s4, v13
    v_exp_f32 v20, v20
    v_exp_f32 v21, v21
    v_fract_f32 v22, v22
    v_fract_f32 v23, v23
    v_cos_f32 v16, v22
    v_cos_f32 v17, v23
    v_sin_f32 v18, v22
    v_sin_f32 v19, v23
    v_pk_mul_f32 v[16:17], v[16:17], v[20:21]
    v_pk_mul_f32 v[18:19], v[18:19], v[20:21]
    v_mov_b32 v46, 0x3f803f80
    v_mov_b32 v47, 0
    ds_write_b64 v168, v[46:47]
    v_pk_mul_f32 v[32:33], v[16:17], v[16:17]
    v_pk_mul_f32 v[34:35], v[16:17], v[18:19]
    v_pk_fma_f32 v[48:49], v[18:19], v[18:19], v[32:33] neg_lo:[1,0,0] neg_hi:[1,0,0]
    v_pk_fma_f32 v[50:51], v[18:19], v[16:17], v[34:35]
    v_cvt_pk_bf16_f32 v40, v48, v49
    v_cvt_pk_bf16_f32 v41, v50, v51
    ds_write_b64 v168, v[40:41] offset:1088
    v_cvt_pk_bf16_f32 v42, v16, v17
    v_cvt_pk_bf16_f32 v43, v18, v19
    ds_write_b64 v168, v[42:43] offset:544
    v_pk_mul_f32 v[32:33], v[16:17], v[48:49]
    v_pk_mul_f32 v[34:35], v[16:17], v[50:51]
    v_pk_mul_f32 v[36:37], v[48:49], v[48:49]
    v_pk_mul_f32 v[38:39], v[48:49], v[50:51]
    v_pk_fma_f32 v[64:65], v[18:19], v[50:51], v[32:33] neg_lo:[1,0,0] neg_hi:[1,0,0]
    v_pk_fma_f32 v[66:67], v[18:19], v[48:49], v[34:35]
    v_pk_fma_f32 v[68:69], v[50:51], v[50:51], v[36:37] neg_lo:[1,0,0] neg_hi:[1,0,0]
    v_pk_fma_f32 v[70:71], v[50:51], v[48:49], v[38:39]
    v_cvt_pk_bf16_f32 v44, v64, v65
    v_cvt_pk_bf16_f32 v45, v66, v67
    ds_write_b64 v168, v[44:45] offset:1632
    v_cvt_pk_bf16_f32 v46, v68, v69
    v_cvt_pk_bf16_f32 v47, v70, v71
    ds_write_b64 v168, v[46:47] offset:2176
    v_pk_mul_f32 v[32:33], v[64:65], v[48:49]
    v_pk_mul_f32 v[34:35], v[64:65], v[50:51]
    v_pk_mul_f32 v[36:37], v[68:69], v[48:49]
    v_pk_mul_f32 v[38:39], v[68:69], v[50:51]
    v_pk_fma_f32 v[72:73], v[66:67], v[50:51], v[32:33] neg_lo:[1,0,0] neg_hi:[1,0,0]
    v_pk_fma_f32 v[74:75], v[66:67], v[48:49], v[34:35]
    v_pk_fma_f32 v[76:77], v[70:71], v[50:51], v[36:37] neg_lo:[1,0,0] neg_hi:[1,0,0]
    v_pk_fma_f32 v[78:79], v[70:71], v[48:49], v[38:39]
    v_cvt_pk_bf16_f32 v40, v72, v73
    v_cvt_pk_bf16_f32 v41, v74, v75
    ds_write_b64 v168, v[40:41] offset:2720
    v_cvt_pk_bf16_f32 v42, v76, v77
    v_cvt_pk_bf16_f32 v43, v78, v79
    ds_write_b64 v168, v[42:43] offset:3264
    s_waitcnt vmcnt(2)
    v_pk_mov_b32 v[96:97], v[116:117], v[118:119] op_sel:[0,0]
PG0:
    s_cbranch_execz WARM0_0_ret
    v_pk_mov_b32 v[98:99], v[120:121], v[122:123] op_sel:[0,0]
    global_store_dwordx4 v112, v[96:99], s[42:43] sc1
    v_pk_mov_b32 v[100:101], v[116:117], v[118:119] op_sel:[1,1]
    v_pk_mov_b32 v[102:103], v[120:121], v[122:123] op_sel:[1,1]
    global_store_dwordx4 v113, v[100:103], s[42:43] sc1
    v_lshl_add_u32 v104, v97, 1, v96
    v_lshl_add_u32 v105, v101, 1, v100
    v_add3_u32 v106, v97, v98, v99
    v_add3_u32 v107, v101, v102, v103
    v_lshl_add_u32 v104, v98, 2, v104
    v_lshl_add_u32 v105, v102, 2, v105
    v_lshl_add_u32 v104, v99, 3, v104
    v_lshl_add_u32 v105, v103, 3, v105
    v_add3_u32 v104, v104, v106, s44
    v_add3_u32 v105, v105, v107, s44
    global_store_dwordx2 v114, v[104:105], s[42:43] sc1
    global_load_dword v254, v194, s[12:13]
    s_cmp_eq_u32 s3, 2
    s_cbranch_scc0 A_noxcx_1
    v_cmp_eq_u32 vcc, s48, v1
    s_nop 0
    s_mov_b64 exec, vcc
    global_store_dword v193, v192, s[42:43] sc1
    s_mov_b64 exec, -1
A_noxcx_1:
    v_pk_mul_f32 v[32:33], v[72:73], v[48:49]
    v_pk_mul_f32 v[34:35], v[72:73], v[50:51]
    v_pk_mul_f32 v[36:37], v[76:77], v[48:49]
    v_pk_mul_f32 v[38:39], v[76:77], v[50:51]
    v_pk_fma_f32 v[64:65], v[74:75], v[50:51], v[32:33] neg_lo:[1,0,0] neg_hi:[1,0,0]
    v_pk_fma_f32 v[66:67], v[74:75], v[48:49], v[34:35]
    v_pk_fma_f32 v[68:69], v[78:79], v[50:51], v[36:37] neg_lo:[1,0,0] neg_hi:[1,0,0]
    v_pk_fma_f32 v[70:71], v[78:79], v[48:49], v[38:39]
    v_cvt_pk_bf16_f32 v44, v64, v65
    v_cvt_pk_bf16_f32 v45, v66, v67
    ds_write_b64 v168, v[44:45] offset:3808
    v_cvt_pk_bf16_f32 v46, v68, v69
    v_cvt_pk_bf16_f32 v47, v70, v71
    ds_write_b64 v168, v[46:47] offset:4352
    v_pk_mul_f32 v[32:33], v[64:65], v[48:49]
    v_pk_mul_f32 v[34:35], v[64:65], v[50:51]
    v_pk_mul_f32 v[36:37], v[68:69], v[48:49]
    v_pk_mul_f32 v[38:39], v[68:69], v[50:51]
    v_pk_fma_f32 v[72:73], v[66:67], v[50:51], v[32:33] neg_lo:[1,0,0] neg_hi:[1,0,0]
    v_pk_fma_f32 v[74:75], v[66:67], v[48:49], v[34:35]
    v_pk_fma_f32 v[76:77], v[70:71], v[50:51], v[36:37] neg_lo:[1,0,0] neg_hi:[1,0,0]
    v_pk_fma_f32 v[78:79], v[70:71], v[48:49], v[38:39]
    v_cvt_pk_bf16_f32 v40, v72, v73
    v_cvt_pk_bf16_f32 v41, v74, v75
    ds_write_b64 v168, v[40:41] offset:4896
    v_cvt_pk_bf16_f32 v42, v76, v77
    v_cvt_pk_bf16_f32 v43, v78, v79
    ds_write_b64 v168, v[42:43] offset:5440
    v_pk_mul_f32 v[32:33], v[72:73], v[48:49]
    v_pk_mul_f32 v[34:35], v[72:73], v[50:51]
    v_pk_mul_f32 v[36:37], v[76:77], v[48:49]
    v_pk_mul_f32 v[38:39], v[76:77], v[50:51]
    v_pk_fma_f32 v[64:65], v[74:75], v[50:51], v[32:33] neg_lo:[1,0,0] neg_hi:[1,0,0]
    v_pk_fma_f32 v[66:67], v[74:75], v[48:49], v[34:35]
    v_pk_fma_f32 v[68:69], v[78:79], v[50:51], v[36:37] neg_lo:[1,0,0] neg_hi:[1,0,0]
    v_pk_fma_f32 v[70:71], v[78:79], v[48:49], v[38:39]
    v_cvt_pk_bf16_f32 v44, v64, v65
    v_cvt_pk_bf16_f32 v45, v66, v67
    ds_write_b64 v168, v[44:45] offset:5984
    v_cvt_pk_bf16_f32 v46, v68, v69
    v_cvt_pk_bf16_f32 v47, v70, v71
    ds_write_b64 v168, v[46:47] offset:6528
    v_pk_mul_f32 v[32:33], v[64:65], v[48:49]
    v_pk_mul_f32 v[34:35], v[64:65], v[50:51]
    v_pk_mul_f32 v[36:37], v[68:69], v[48:49]
    v_pk_mul_f32 v[38:39], v[68:69], v[50:51]
    v_pk_fma_f32 v[72:73], v[66:67], v[50:51], v[32:33] neg_lo:[1,0,0] neg_hi:[1,0,0]
    v_pk_fma_f32 v[74:75], v[66:67], v[48:49], v[34:35]
    v_pk_fma_f32 v[76:77], v[70:71], v[50:51], v[36:37] neg_lo:[1,0,0] neg_hi:[1,0,0]
    v_pk_fma_f32 v[78:79], v[70:71], v[48:49], v[38:39]
    v_cvt_pk_bf16_f32 v40, v72, v73
    v_cvt_pk_bf16_f32 v41, v74, v75
    ds_write_b64 v168, v[40:41] offset:7072
    v_cvt_pk_bf16_f32 v42, v76, v77
    v_cvt_pk_bf16_f32 v43, v78, v79
    ds_write_b64 v168, v[42:43] offset:7616
    v_pk_mul_f32 v[32:33], v[72:73], v[48:49]
    v_pk_mul_f32 v[34:35], v[72:73], v[50:51]
    v_pk_mul_f32 v[36:37], v[76:77], v[48:49]
    v_pk_mul_f32 v[38:39], v[76:77], v[50:51]
    v_pk_fma_f32 v[64:65], v[74:75], v[50:51], v[32:33] neg_lo:[1,0,0] neg_hi:[1,0,0]
    v_pk_fma_f32 v[66:67], v[74:75], v[48:49], v[34:35]
    v_pk_fma_f32 v[68:69], v[78:79], v[50:51], v[36:37] neg_lo:[1,0,0] neg_hi:[1,0,0]
    v_pk_fma_f32 v[70:71], v[78:79], v[48:49], v[38:39]
    v_cvt_pk_bf16_f32 v44, v64, v65
    v_cvt_pk_bf16_f32 v45, v66, v67
    ds_write_b64 v168, v[44:45] offset:8160
    v_cvt_pk_bf16_f32 v46, v68, v69
    v_cvt_pk_bf16_f32 v47, v70, v71
    ds_write_b64 v168, v[46:47] offset:8704
    v_pk_mul_f32 v[32:33], v[64:65], v[48:49]
    v_pk_mul_f32 v[34:35], v[64:65], v[50:51]
    v_pk_mul_f32 v[36:37], v[68:69], v[48:49]
    v_pk_mul_f32 v[38:39], v[68:69], v[50:51]
    v_pk_fma_f32 v[72:73], v[66:67], v[50:51], v[32:33] neg_lo:[1,0,0] neg_hi:[1,0,0]
    v_pk_fma_f32 v[74:75], v[66:67], v[48:49], v[34:35]
    v_pk_fma_f32 v[76:77], v[70:71], v[50:51], v[36:37] neg_lo:[1,0,0] neg_hi:[1,0,0]
    v_pk_fma_f32 v[78:79], v[70:71], v[48:49], v[38:39]
    v_cvt_pk_bf16_f32 v40, v72, v73
    v_cvt_pk_bf16_f32 v41, v74, v75
    ds_write_b64 v168, v[40:41] offset:9248
    v_cvt_pk_bf16_f32 v42, v76, v77
    v_cvt_pk_bf16_f32 v43, v78, v79
    ds_write_b64 v168, v[42:43] offset:9792
    v_pk_mul_f32 v[32:33], v[72:73], v[48:49]
    v_pk_mul_f32 v[34:35], v[72:73], v[50:51]
    v_pk_mul_f32 v[36:37], v[76:77], v[48:49]
    v_pk_mul_f32 v[38:39], v[76:77], v[50:51]
    v_pk_fma_f32 v[64:65], v[74:75], v[50:51], v[32:33] neg_lo:[1,0,0] neg_hi:[1,0,0]
    v_pk_fma_f32 v[66:67], v[74:75], v[48:49], v[34:35]
    v_pk_fma_f32 v[68:69], v[78:79], v[50:51], v[36:37] neg_lo:[1,0,0] neg_hi:[1,0,0]
    v_pk_fma_f32 v[70:71], v[78:79], v[48:49], v[38:39]
    v_cvt_pk_bf16_f32 v44, v64, v65
    v_cvt_pk_bf16_f32 v45, v66, v67
    ds_write_b64 v168, v[44:45] offset:10336
    v_cvt_pk_bf16_f32 v46, v68, v69
    v_cvt_pk_bf16_f32 v47, v70, v71
    ds_write_b64 v168, v[46:47] offset:10880
    v_pk_mul_f32 v[32:33], v[64:65], v[48:49]
    v_pk_mul_f32 v[34:35], v[64:65], v[50:51]
    v_pk_mul_f32 v[36:37], v[68:69], v[48:49]
    v_pk_mul_f32 v[38:39], v[68:69], v[50:51]
    v_pk_fma_f32 v[72:73], v[66:67], v[50:51], v[32:33] neg_lo:[1,0,0] neg_hi:[1,0,0]
    v_pk_fma_f32 v[74:75], v[66:67], v[48:49], v[34:35]
    v_pk_fma_f32 v[76:77], v[70:71], v[50:51], v[36:37] neg_lo:[1,0,0] neg_hi:[1,0,0]
    v_pk_fma_f32 v[78:79], v[70:71], v[48:49], v[38:39]
    v_cvt_pk_bf16_f32 v40, v72, v73
    v_cvt_pk_bf16_f32 v41, v74, v75
    ds_write_b64 v168, v[40:41] offset:11424
    v_cvt_pk_bf16_f32 v42, v76, v77
    v_cvt_pk_bf16_f32 v43, v78, v79
    ds_write_b64 v168, v[42:43] offset:11968
    v_pk_mul_f32 v[32:33], v[72:73], v[48:49]
    v_pk_mul_f32 v[34:35], v[72:73], v[50:51]
    v_pk_mul_f32 v[36:37], v[76:77], v[48:49]
    v_pk_mul_f32 v[38:39], v[76:77], v[50:51]
    v_pk_fma_f32 v[64:65], v[74:75], v[50:51], v[32:33] neg_lo:[1,0,0] neg_hi:[1,0,0]
    v_pk_fma_f32 v[66:67], v[74:75], v[48:49], v[34:35]
    v_pk_fma_f32 v[68:69], v[78:79], v[50:51], v[36:37] neg_lo:[1,0,0] neg_hi:[1,0,0]
    v_pk_fma_f32 v[70:71], v[78:79], v[48:49], v[38:39]
    v_cvt_pk_bf16_f32 v44, v64, v65
    v_cvt_pk_bf16_f32 v45, v66, v67
    ds_write_b64 v168, v[44:45] offset:12512
    v_cvt_pk_bf16_f32 v46, v68, v69
    v_cvt_pk_bf16_f32 v47, v70, v71
    ds_write_b64 v168, v[46:47] offset:13056
    v_pk_mul_f32 v[32:33], v[64:65], v[48:49]
    v_pk_mul_f32 v[34:35], v[64:65], v[50:51]
    v_pk_mul_f32 v[36:37], v[68:69], v[48:49]
    v_pk_mul_f32 v[38:39], v[68:69], v[50:51]
    v_pk_fma_f32 v[72:73], v[66:67], v[50:51], v[32:33] neg_lo:[1,0,0] neg_hi:[1,0,0]
    v_pk_fma_f32 v[74:75], v[66:67], v[48:49], v[34:35]
    v_pk_fma_f32 v[76:77], v[70:71], v[50:51], v[36:37] neg_lo:[1,0,0] neg_hi:[1,0,0]
    v_pk_fma_f32 v[78:79], v[70:71], v[48:49], v[38:39]
    v_cvt_pk_bf16_f32 v40, v72, v73
    v_cvt_pk_bf16_f32 v41, v74, v75
    ds_write_b64 v168, v[40:41] offset:13600
    v_cvt_pk_bf16_f32 v42, v76, v77
    v_cvt_pk_bf16_f32 v43, v78, v79
    ds_write_b64 v168, v[42:43] offset:14144
    v_pk_mul_f32 v[32:33], v[72:73], v[48:49]
    v_pk_mul_f32 v[34:35], v[72:73], v[50:51]
    v_pk_mul_f32 v[36:37], v[76:77], v[48:49]
    v_pk_mul_f32 v[38:39], v[76:77], v[50:51]
    v_pk_fma_f32 v[64:65], v[74:75], v[50:51], v[32:33] neg_lo:[1,0,0] neg_hi:[1,0,0]
    v_pk_fma_f32 v[66:67], v[74:75], v[48:49], v[34:35]
    v_pk_fma_f32 v[68:69], v[78:79], v[50:51], v[36:37] neg_lo:[1,0,0] neg_hi:[1,0,0]
    v_pk_fma_f32 v[70:71], v[78:79], v[48:49], v[38:39]
    v_cvt_pk_bf16_f32 v44, v64, v65
    v_cvt_pk_bf16_f32 v45, v66, v67
    ds_write_b64 v168, v[44:45] offset:14688
    v_cvt_pk_bf16_f32 v46, v68, v69
    v_cvt_pk_bf16_f32 v47, v70, v71
    ds_write_b64 v168, v[46:47] offset:15232
    v_pk_mul_f32 v[32:33], v[64:65], v[48:49]
    v_pk_mul_f32 v[34:35], v[64:65], v[50:51]
    v_pk_mul_f32 v[36:37], v[68:69], v[48:49]
    v_pk_mul_f32 v[38:39], v[68:69], v[50:51]
    v_pk_fma_f32 v[72:73], v[66:67], v[50:51], v[32:33] neg_lo:[1,0,0] neg_hi:[1,0,0]
    v_pk_fma_f32 v[74:75], v[66:67], v[48:49], v[34:35]
    v_pk_fma_f32 v[76:77], v[70:71], v[50:51], v[36:37] neg_lo:[1,0,0] neg_hi:[1,0,0]
    v_pk_fma_f32 v[78:79], v[70:71], v[48:49], v[38:39]
    v_cvt_pk_bf16_f32 v40, v72, v73
    v_cvt_pk_bf16_f32 v41, v74, v75
    ds_write_b64 v168, v[40:41] offset:15776
    v_cvt_pk_bf16_f32 v42, v76, v77
    v_cvt_pk_bf16_f32 v43, v78, v79
    ds_write_b64 v168, v[42:43] offset:16320
    v_pk_mul_f32 v[32:33], v[72:73], v[48:49]
    v_pk_mul_f32 v[34:35], v[72:73], v[50:51]
    v_pk_fma_f32 v[64:65], v[74:75], v[50:51], v[32:33] neg_lo:[1,0,0] neg_hi:[1,0,0]
    v_pk_fma_f32 v[66:67], v[74:75], v[48:49], v[34:35]
    v_cvt_pk_bf16_f32 v44, v64, v65
    v_cvt_pk_bf16_f32 v45, v66, v67
    ds_write_b64 v168, v[44:45] offset:16864
    s_branch A_kg_done
A_xwave:
PG1:
    s_cbranch_execz WARM0_0_ret
    v_sub_f32 v12, 0, v12
    v_sub_f32 v13, 0, v13
    v_lshlrev_b32 v24, 16, v26
    v_and_b32 v25, 0xffff0000, v26
    v_lshlrev_b32 v26, 16, v27
    v_and_b32 v27, 0xffff0000, v27
    v_add_f32 v9, v57, v57
    v_exp_f32 v20, v10
    v_exp_f32 v21, v11
    v_fract_f32 v22, v12
    v_fract_f32 v23, v13
    v_cos_f32 v16, v22
    v_cos_f32 v17, v23
    v_sin_f32 v18, v22
    v_sin_f32 v19, v23
    v_pk_mul_f32 v[16:17], v[16:17], v[20:21]
    v_pk_mul_f32 v[18:19], v[18:19], v[20:21]
    v_mul_f32 v24, v9, v24
    v_mul_f32 v25, v9, v25
    v_mul_f32 v26, -v9, v26
    v_mul_f32 v27, -v9, v27
    s_mov_b32 s4, 0x43800000
    v_mul_f32 v20, s4, v10
    v_mul_f32 v22, s4, v12
    v_mul_f32 v21, s4, v11
    v_mul_f32 v23, s4, v13
    v_exp_f32 v20, v20
    v_exp_f32 v21, v21
    v_fract_f32 v22, v22
    v_fract_f32 v23, v23
    v_cos_f32 v48, v22
    v_cos_f32 v49, v23
    v_sin_f32 v50, v22
    v_sin_f32 v51, v23
    v_pk_mul_f32 v[48:49], v[48:49], v[20:21]
    v_pk_mul_f32 v[50:51], v[50:51], v[20:21]
    v_cvt_pk_bf16_f32 v40, v24, v25
    v_cvt_pk_bf16_f32 v41, v26, v27
    ds_write_b64 v168, v[40:41] offset:0
    v_pk_mul_f32 v[32:33], v[24:25], v[16:17]
    v_pk_mul_f32 v[34:35], v[24:25], v[18:19]
    v_pk_mul_f32 v[36:37], v[16:17], v[16:17]
    v_pk_mul_f32 v[38:39], v[16:17], v[18:19]
    v_pk_fma_f32 v[64:65], v[26:27], v[18:19], v[32:33] neg_lo:[1,0,0] neg_hi:[1,0,0]
    v_pk_fma_f32 v[66:67], v[26:27], v[16:17], v[34:35]
    v_pk_fma_f32 v[52:53], v[18:19], v[18:19], v[36:37] neg_lo:[1,0,0] neg_hi:[1,0,0]
    v_pk_fma_f32 v[54:55], v[18:19], v[16:17], v[38:39]
    v_cvt_pk_bf16_f32 v42, v64, v65
    v_cvt_pk_bf16_f32 v43, v66, v67
    ds_write_b64 v168, v[42:43] offset:544
    v_pk_mul_f32 v[32:33], v[24:25], v[52:53]
    v_pk_mul_f32 v[34:35], v[24:25], v[54:55]
    v_pk_mul_f32 v[36:37], v[52:53], v[52:53]
    v_pk_mul_f32 v[38:39], v[52:53], v[54:55]
    v_pk_fma_f32 v[68:69], v[26:27], v[54:55], v[32:33] neg_lo:[1,0,0] neg_hi:[1,0,0]
    v_pk_fma_f32 v[70:71], v[26:27], v[52:53], v[34:35]
    v_pk_fma_f32 v[56:57], v[54:55], v[54:55], v[36:37] neg_lo:[1,0,0] neg_hi:[1,0,0]
    v_pk_fma_f32 v[58:59], v[54:55], v[52:53], v[38:39]
    v_cvt_pk_bf16_f32 v44, v68, v69
    v_cvt_pk_bf16_f32 v45, v70, v71
    ds_write_b64 v168, v[44:45] offset:1088
    v_pk_mul_f32 v[32:33], v[64:65], v[52:53]
    v_pk_mul_f32 v[34:35], v[64:65], v[54:55]
    v_pk_mul_f32 v[36:37], v[56:57], v[56:57]
    v_pk_mul_f32 v[38:39], v[56:57], v[58:59]
    v_pk_fma_f32 v[72:73], v[66:67], v[54:55], v[32:33] neg_lo:[1,0,0] neg_hi:[1,0,0]
    v_pk_fma_f32 v[74:75], v[66:67], v[52:53], v[34:35]
    v_pk_fma_f32 v[60:61], v[58:59], v[58:59], v[36:37] neg_lo:[1,0,0] neg_hi:[1,0,0]
    v_pk_fma_f32 v[62:63], v[58:59], v[56:57], v[38:39]
    v_cvt_pk_bf16_f32 v46, v72, v73
    v_cvt_pk_bf16_f32 v47, v74, v75
    ds_write_b64 v168, v[46:47] offset:1632
    v_pk_mul_f32 v[32:33], v[24:25], v[56:57]
    v_pk_mul_f32 v[34:35], v[24:25], v[58:59]
    v_pk_mul_f32 v[36:37], v[64:65], v[56:57]
    v_pk_mul_f32 v[38:39], v[64:65], v[58:59]
    v_pk_fma_f32 v[76:77], v[26:27], v[58:59], v[32:33] neg_lo:[1,0,0] neg_hi:[1,0,0]
    v_pk_fma_f32 v[78:79], v[26:27], v[56:57], v[34:35]
    v_pk_fma_f32 v[80:81], v[66:67], v[58:59], v[36:37] neg_lo:[1,0,0] neg_hi:[1,0,0]
    v_pk_fma_f32 v[82:83], v[66:67], v[56:57], v[38:39]
    v_cvt_pk_bf16_f32 v40, v76, v77
    v_cvt_pk_bf16_f32 v41, v78, v79
    ds_write_b64 v168, v[40:41] offset:2176
    v_cvt_pk_bf16_f32 v42, v80, v81
    v_cvt_pk_bf16_f32 v43, v82, v83
    ds_write_b64 v168, v[42:43] offset:2720
    s_waitcnt vmcnt(2)
    v_pk_mov_b32 v[96:97], v[116:117], v[118:119] op_sel:[0,0]
    v_pk_mov_b32 v[98:99], v[120:121], v[122:123] op_sel:[0,0]
    global_store_dwordx4 v112, v[96:99], s[42:43] sc1
    v_pk_mov_b32 v[100:101], v[116:117], v[118:119] op_sel:[1,1]
    v_pk_mov_b32 v[102:103], v[120:121], v[122:123] op_sel:[1,1]
    global_store_dwordx4 v113, v[100:103], s[42:43] sc1
    v_lshl_add_u32 v104, v97, 1, v96
    v_lshl_add_u32 v105, v101, 1, v100
    v_add3_u32 v106, v97, v98, v99
    v_add3_u32 v107, v101, v102, v103
    v_lshl_add_u32 v104, v98, 2, v104
    v_lshl_add_u32 v105, v102, 2, v105
    v_lshl_add_u32 v104, v99, 3, v104
    v_lshl_add_u32 v105, v103, 3, v105
    v_add3_u32 v104, v104, v106, s44
    v_add3_u32 v105, v105, v107, s44
    global_store_dwordx2 v114, v[104:105], s[42:43] sc1
    global_load_dword v254, v194, s[12:13]
    s_cmp_eq_u32 s3, 2
    s_cbranch_scc0 A_noxcx_2
    v_cmp_eq_u32 vcc, s48, v1
    s_nop 0
    s_mov_b64 exec, vcc
    global_store_dword v193, v192, s[42:43] sc1
    s_mov_b64 exec, -1
A_noxcx_2:
    v_pk_mul_f32 v[32:33], v[68:69], v[56:57]
    v_pk_mul_f32 v[34:35], v[68:69], v[58:59]
    v_pk_mul_f32 v[36:37], v[72:73], v[56:57]
    v_pk_mul_f32 v[38:39], v[72:73], v[58:59]
    v_pk_fma_f32 v[76:77], v[70:71], v[58:59], v[32:33] neg_lo:[1,0,0] neg_hi:[1,0,0]
    v_pk_fma_f32 v[78:79], v[70:71], v[56:57], v[34:35]
    v_pk_fma_f32 v[80:81], v[74:75], v[58:59], v[36:37] neg_lo:[1,0,0] neg_hi:[1,0,0]
    v_pk_fma_f32 v[82:83], v[74:75], v[56:57], v[38:39]
    v_cvt_pk_bf16_f32 v44, v76, v77
    v_cvt_pk_bf16_f32 v45, v78, v79
    ds_write_b64 v168, v[44:45] offset:3264
    v_cvt_pk_bf16_f32 v46, v80, v81
    v_cvt_pk_bf16_f32 v47, v82, v83
    ds_write_b64 v168, v[46:47] offset:3808
    v_pk_mul_f32 v[32:33], v[24:25], v[48:49]
    v_pk_mul_f32 v[34:35], v[24:25], v[50:51]
    v_pk_fma_f32 v[84:85], v[26:27], v[50:51], v[32:33] neg_lo:[1,0,0] neg_hi:[1,0,0]
    v_pk_fma_f32 v[86:87], v[26:27], v[48:49], v[34:35]
    v_cvt_pk_bf16_f32 v40, v84, v85
    v_cvt_pk_bf16_f32 v41, v86, v87
    ds_write_b64 v168, v[40:41] offset:4352
    v_pk_mul_f32 v[32:33], v[84:85], v[52:53]
    v_pk_mul_f32 v[34:35], v[84:85], v[54:55]
    v_pk_mul_f32 v[36:37], v[84:85], v[48:49]
    v_pk_mul_f32 v[38:39], v[84:85], v[50:51]
    v_pk_fma_f32 v[64:65], v[86:87], v[54:55], v[32:33] neg_lo:[1,0,0] neg_hi:[1,0,0]
    v_pk_fma_f32 v[66:67], v[86:87], v[52:53], v[34:35]
    v_pk_fma_f32 v[88:89], v[86:87], v[50:51], v[36:37] neg_lo:[1,0,0] neg_hi:[1,0,0]
    v_pk_fma_f32 v[90:91], v[86:87], v[48:49], v[38:39]
    v_cvt_pk_bf16_f32 v42, v64, v65
    v_cvt_pk_bf16_f32 v43, v66, v67
    ds_write_b64 v168, v[42:43] offset:4896
    v_cvt_pk_bf16_f32 v44, v88, v89
    v_cvt_pk_bf16_f32 v45, v90, v91
    ds_write_b64 v168, v[44:45] offset:8704
    v_pk_mul_f32 v[32:33], v[84:85], v[56:57]
    v_pk_mul_f32 v[34:35], v[84:85], v[58:59]
    v_pk_mul_f32 v[36:37], v[84:85], v[60:61]
    v_pk_mul_f32 v[38:39], v[84:85], v[62:63]
    v_pk_fma_f32 v[68:69], v[86:87], v[58:59], v[32:33] neg_lo:[1,0,0] neg_hi:[1,0,0]
    v_pk_fma_f32 v[70:71], v[86:87], v[56:57], v[34:35]
    v_pk_fma_f32 v[72:73], v[86:87], v[62:63], v[36:37] neg_lo:[1,0,0] neg_hi:[1,0,0]
    v_pk_fma_f32 v[74:75], v[86:87], v[60:61], v[38:39]
    v_cvt_pk_bf16_f32 v46, v68, v69
    v_cvt_pk_bf16_f32 v47, v70, v71
    ds_write_b64 v168, v[46:47] offset:5440
    ds_write_b64 v168, v[46:47] offset:6528
    v_cvt_pk_bf16_f32 v40, v72, v73
    v_cvt_pk_bf16_f32 v41, v74, v75
    ds_write_b64 v168, v[40:41] offset:7616
    v_pk_mul_f32 v[32:33], v[64:65], v[56:57]
    v_pk_mul_f32 v[34:35], v[64:65], v[58:59]
    v_pk_mul_f32 v[36:37], v[88:89], v[48:49]
    v_pk_mul_f32 v[38:39], v[88:89], v[50:51]
    v_pk_fma_f32 v[68:69], v[66:67], v[58:59], v[32:33] neg_lo:[1,0,0] neg_hi:[1,0,0]
    v_pk_fma_f32 v[70:71], v[66:67], v[56:57], v[34:35]
    v_pk_fma_f32 v[92:93], v[90:91], v[50:51], v[36:37] neg_lo:[1,0,0] neg_hi:[1,0,0]
    v_pk_fma_f32 v[94:95], v[90:91], v[48:49], v[38:39]
    v_cvt_pk_bf16_f32 v42, v68, v69
    v_cvt_pk_bf16_f32 v43, v70, v71
    ds_write_b64 v168, v[42:43] offset:7072
    v_cvt_pk_bf16_f32 v44, v92, v93
    v_cvt_pk_bf16_f32 v45, v94, v95
    ds_write_b64 v168, v[44:45] offset:10880
    v_pk_mul_f32 v[32:33], v[88:89], v[56:57]
    v_pk_mul_f32 v[34:35], v[88:89], v[58:59]
    v_pk_mul_f32 v[36:37], v[88:89], v[60:61]
    v_pk_mul_f32 v[38:39], v[88:89], v[62:63]
    v_pk_fma_f32 v[64:65], v[90:91], v[58:59], v[32:33] neg_lo:[1,0,0] neg_hi:[1,0,0]
    v_pk_fma_f32 v[66:67], v[90:91], v[56:57], v[34:35]
    v_pk_fma_f32 v[72:73], v[90:91], v[62:63], v[36:37] neg_lo:[1,0,0] neg_hi:[1,0,0]
    v_pk_fma_f32 v[74:75], v[90:91], v[60:61], v[38:39]
    v_cvt_pk_bf16_f32 v46, v64, v65
    v_cvt_pk_bf16_f32 v47, v66, v67
    ds_write_b64 v168, v[46:47] offset:9248
    v_cvt_pk_bf16_f32 v40, v72, v73
    v_cvt_pk_bf16_f32 v41, v74, v75
    ds_write_b64 v168, v[40:41] offset:9792
    v_pk_mul_f32 v[32:33], v[92:93], v[56:57]
    v_pk_mul_f32 v[34:35], v[92:93], v[58:59]
    v_pk_mul_f32 v[36:37], v[92:93], v[48:49]
    v_pk_mul_f32 v[38:39], v[92:93], v[50:51]
    v_pk_fma_f32 v[64:65], v[94:95], v[58:59], v[32:33] neg_lo:[1,0,0] neg_hi:[1,0,0]
    v_pk_fma_f32 v[66:67], v[94:95], v[56:57], v[34:35]
    v_pk_fma_f32 v[84:85], v[94:95], v[50:51], v[36:37] neg_lo:[1,0,0] neg_hi:[1,0,0]
    v_pk_fma_f32 v[86:87], v[94:95], v[48:49], v[38:39]
    v_cvt_pk_bf16_f32 v42, v64, v65
    v_cvt_pk_bf16_f32 v43, v66, v67
    ds_write_b64 v168, v[42:43] offset:11424
    v_cvt_pk_bf16_f32 v44, v84, v85
    v_cvt_pk_bf16_f32 v45, v86, v87
    ds_write_b64 v168, v[44:45] offset:13056
    v_pk_mul_f32 v[32:33], v[92:93], v[60:61]
    v_pk_mul_f32 v[34:35], v[92:93], v[62:63]
    v_pk_mul_f32 v[36:37], v[84:85], v[48:49]
    v_pk_mul_f32 v[38:39], v[84:85], v[50:51]
    v_pk_fma_f32 v[68:69], v[94:95], v[62:63], v[32:33] neg_lo:[1,0,0] neg_hi:[1,0,0]
    v_pk_fma_f32 v[70:71], v[94:95], v[60:61], v[34:35]
    v_pk_fma_f32 v[88:89], v[86:87], v[50:51], v[36:37] neg_lo:[1,0,0] neg_hi:[1,0,0]
    v_pk_fma_f32 v[90:91], v[86:87], v[48:49], v[38:39]
    v_cvt_pk_bf16_f32 v46, v68, v69
    v_cvt_pk_bf16_f32 v47, v70, v71
    ds_write_b64 v168, v[46:47] offset:11968
    v_cvt_pk_bf16_f32 v40, v88, v89
    v_cvt_pk_bf16_f32 v41, v90, v91
    ds_write_b64 v168, v[40:41] offset:14144
    v_pk_mul_f32 v[32:33], v[84:85], v[60:61]
    v_pk_mul_f32 v[34:35], v[84:85], v[62:63]
    v_pk_mul_f32 v[36:37], v[88:89], v[48:49]
    v_pk_mul_f32 v[38:39], v[88:89], v[50:51]
    v_pk_fma_f32 v[64:65], v[86:87], v[62:63], v[32:33] neg_lo:[1,0,0] neg_hi:[1,0,0]
    v_pk_fma_f32 v[66:67], v[86:87], v[60:61], v[34:35]
    v_pk_fma_f32 v[92:93], v[90:91], v[50:51], v[36:37] neg_lo:[1,0,0] neg_hi:[1,0,0]
    v_pk_fma_f32 v[94:95], v[90:91], v[48:49], v[38:39]
    v_cvt_pk_bf16_f32 v42, v64, v65
    v_cvt_pk_bf16_f32 v43, v66, v67
    ds_write_b64 v168, v[42:43] offset:13600
    v_cvt_pk_bf16_f32 v44, v92, v93
    v_cvt_pk_bf16_f32 v45, v94, v95
    ds_write_b64 v168, v[44:45] offset:15232
    v_pk_mul_f32 v[32:33], v[88:89], v[60:61]
    v_pk_mul_f32 v[34:35], v[88:89], v[62:63]
    v_pk_mul_f32 v[36:37], v[92:93], v[48:49]
    v_pk_mul_f32 v[38:39], v[92:93], v[50:51]
    v_pk_fma_f32 v[68:69], v[90:91], v[62:63], v[32:33] neg_lo:[1,0,0] neg_hi:[1,0,0]
    v_pk_fma_f32 v[70:71], v[90:91], v[60:61], v[34:35]
    v_pk_fma_f32 v[84:85], v[94:95], v[50:51], v[36:37] neg_lo:[1,0,0] neg_hi:[1,0,0]
    v_pk_fma_f32 v[86:87], v[94:95], v[48:49], v[38:39]
    v_cvt_pk_bf16_f32 v46, v68, v69
    v_cvt_pk_bf16_f32 v47, v70, v71
    ds_write_b64 v168, v[46:47] offset:14688
    v_cvt_pk_bf16_f32 v40, v84, v85
    v_cvt_pk_bf16_f32 v41, v86, v87
    ds_write_b64 v168, v[40:41] offset:16320
    v_pk_mul_f32 v[32:33], v[92:93], v[60:61]
    v_pk_mul_f32 v[34:35], v[92:93], v[62:63]
    v_pk_mul_f32 v[36:37], v[84:85], v[60:61]
    v_pk_mul_f32 v[38:39], v[84:85], v[62:63]
    v_pk_fma_f32 v[64:65], v[94:95], v[62:63], v[32:33] neg_lo:[1,0,0] neg_hi:[1,0,0]
    v_pk_fma_f32 v[66:67], v[94:95], v[60:61], v[34:35]
    v_pk_fma_f32 v[68:69], v[86:87], v[62:63], v[36:37] neg_lo:[1,0,0] neg_hi:[1,0,0]
    v_pk_fma_f32 v[70:71], v[86:87], v[60:61], v[38:39]
    v_cvt_pk_bf16_f32 v42, v64, v65
    v_cvt_pk_bf16_f32 v43, v66, v67
    ds_write_b64 v168, v[42:43] offset:15776
    v_cvt_pk_bf16_f32 v44, v68, v69
    v_cvt_pk_bf16_f32 v45, v70, v71
    ds_write_b64 v168, v[44:45] offset:16864
A_kg_done:
PG2:
    s_cbranch_execz WARM0_0_ret
    s_waitcnt lgkmcnt(0)
    s_barrier
    ds_read_b128 v[16:19], v169 offset:0
    ds_read_b128 v[20:23], v170 offset:0
    ds_read_b128 v[24:27], v170 offset:8704
    ds_read_b128 v[28:31], v169 offset:64
    ds_read_b128 v[32:35], v170 offset:64
    ds_read_b128 v[36:39], v170 offset:8768
    ds_read_b128 v[40:43], v169 offset:128
    ds_read_b128 v[44:47], v170 offset:128
    ds_read_b128 v[48:51], v170 offset:8832
    ds_read_b128 v[52:55], v169 offset:192
    ds_read_b128 v[56:59], v170 offset:192
    ds_read_b128 v[60:63], v170 offset:8896
    s_waitcnt lgkmcnt(9)
    v_mfma_f32_16x16x32_bf16 v[112:115], v[16:19], v[20:23], 0
    v_mfma_f32_16x16x32_bf16 v[116:119], v[16:19], v[24:27], 0
    ds_read_b128 v[64:67], v169 offset:256
    ds_read_b128 v[68:71], v170 offset:256
    ds_read_b128 v[72:75], v170 offset:8960
    global_load_dwordx4 v[228:231], v177, s[42:43] offset:-2048 sc1
    s_waitcnt lgkmcnt(9)
    v_mfma_f32_16x16x32_bf16 v[112:115], v[28:31], v[32:35], v[112:115]
    v_mfma_f32_16x16x32_bf16 v[116:119], v[28:31], v[36:39], v[116:119]
    ds_read_b128 v[76:79], v169 offset:320
    ds_read_b128 v[80:83], v170 offset:320
    ds_read_b128 v[84:87], v170 offset:9024
    global_load_dwordx4 v[232:235], v177, s[42:43] offset:2048 sc1
    s_waitcnt lgkmcnt(9)
    v_mfma_f32_16x16x32_bf16 v[112:115], v[40:43], v[44:47], v[112:115]
    v_mfma_f32_16x16x32_bf16 v[116:119], v[40:43], v[48:51], v[116:119]
    ds_read_b128 v[88:91], v169 offset:384
    ds_read_b128 v[92:95], v170 offset:384
    ds_read_b128 v[96:99], v170 offset:9088
    global_load_dword v236, v178, s[42:43] sc1
    s_waitcnt lgkmcnt(9)
    v_mfma_f32_16x16x32_bf16 v[112:115], v[52:55], v[56:59], v[112:115]
    v_mfma_f32_16x16x32_bf16 v[116:119], v[52:55], v[60:63], v[116:119]
    ds_read_b128 v[100:103], v169 offset:448
    ds_read_b128 v[104:107], v170 offset:448
    ds_read_b128 v[108:111], v170 offset:9152
    global_load_dword v237, v179, s[42:43] sc1
    s_waitcnt lgkmcnt(9)
    v_mfma_f32_16x16x32_bf16 v[112:115], v[64:67], v[68:71], v[112:115]
    v_mfma_f32_16x16x32_bf16 v[116:119], v[64:67], v[72:75], v[116:119]
    global_load_dwordx4 v[212:215], v175, s[42:43] offset:0 sc1
    s_waitcnt lgkmcnt(6)
    v_mfma_f32_16x16x32_bf16 v[112:115], v[76:79], v[80:83], v[112:115]
    v_mfma_f32_16x16x32_bf16 v[116:119], v[76:79], v[84:87], v[116:119]
    global_load_dwordx4 v[216:219], v175, s[42:43] offset:16 sc1
    s_waitcnt lgkmcnt(3)
    v_mfma_f32_16x16x32_bf16 v[112:115], v[88:91], v[92:95], v[112:115]
    v_mfma_f32_16x16x32_bf16 v[116:119], v[88:91], v[96:99], v[116:119]
    global_load_dwordx4 v[220:223], v176, s[42:43] offset:0 sc1
    s_waitcnt lgkmcnt(0)
    v_mfma_f32_16x16x32_bf16 v[112:115], v[100:103], v[104:107], v[112:115]
    v_mfma_f32_16x16x32_bf16 v[116:119], v[100:103], v[108:111], v[116:119]
    global_load_dwordx4 v[224:227], v176, s[42:43] offset:16 sc1
    s_cmp_eq_u32 s50, 0
    s_nop 2
    s_cbranch_scc0 A_exp1
    s_nop 3
    v_cvt_pk_bf16_f32 v16, v112, v113
    v_cvt_pk_bf16_f32 v17, v114, v115
    v_perm_b32 v20, v17, v16, v171
    v_perm_b32 v21, v17, v16, v172
    ds_write_b64 v174, v[20:21] offset:256
    v_cvt_pk_bf16_f32 v16, v116, v117
    v_cvt_pk_bf16_f32 v17, v118, v119
    v_perm_b32 v22, v17, v16, v171
    v_perm_b32 v23, v17, v16, v172
    ds_write_b64 v174, v[22:23] offset:0
    s_branch A_exp_done
A_exp1:
    s_mov_b32 s6, 0x01000100
    v_cvt_pk_bf16_f32 v16, v112, v113
    v_cvt_pk_bf16_f32 v17, v114, v115
    v_perm_b32 v20, v17, v16, v171
    v_perm_b32 v21, v17, v16, v172
    v_perm_b32 v22, v17, v16, v173
PG3:
    s_cbranch_execz WARM0_0_ret
    v_perm_b32 v23, v17, v16, s6
    ds_write_b128 v174, v[20:23] offset:768
    v_cvt_pk_bf16_f32 v18, v116, v117
    v_cvt_pk_bf16_f32 v19, v118, v119
    v_perm_b32 v24, v19, v18, v171
    v_perm_b32 v25, v19, v18, v172
    v_perm_b32 v26, v19, v18, v173
    v_perm_b32 v27, v19, v18, s6
    ds_write_b128 v174, v[24:27] offset:512
    s_mov_b32 exec_lo, 0
    v_perm_b32 v28, v17, v17, v171
    v_perm_b32 v29, v17, v17, v172
    v_perm_b32 v30, v17, v17, v173
    v_perm_b32 v31, v17, v17, s6
    ds_write_b128 v174, v[28:31] offset:256
    v_perm_b32 v32, v19, v19, v171
    v_perm_b32 v33, v19, v19, v172
    v_perm_b32 v34, v19, v19, v173
    v_perm_b32 v35, v19, v19, s6
    ds_write_b128 v174, v[32:35] offset:0
    s_mov_b32 exec_lo, -1
A_exp_done:
    s_waitcnt lgkmcnt(0)
    s_barrier
    ds_read_b128 v[8:11], v181 offset:0
    ds_read_b64 v[12:13], v181 offset:16
    ds_read_b128 v[48:51], v181 offset:16640
    ds_read_b64 v[52:53], v181 offset:16656
    s_waitcnt lgkmcnt(2)
    v_alignbyte_b32 v24, v9, v8, 2
    v_alignbyte_b32 v25, v10, v9, 2
    v_alignbyte_b32 v26, v11, v10, 2
    v_alignbyte_b32 v27, v12, v11, 2
    v_alignbyte_b32 v28, v13, v12, 2
    ds_write_b128 v181, v[24:27] offset:4160
    v_pk_mov_b32 v[32:33], v[8:9], v[10:11] op_sel:[1,0]
    v_pk_mov_b32 v[34:35], v[10:11], v[12:13] op_sel:[1,0]
    v_pk_mov_b32 v[36:37], v[24:25], v[26:27] op_sel:[1,0]
    v_pk_mov_b32 v[38:39], v[26:27], v[28:29] op_sel:[1,0]
    s_waitcnt lgkmcnt(1)
    v_alignbyte_b32 v56, v49, v48, 2
    v_alignbyte_b32 v57, v50, v49, 2
    v_alignbyte_b32 v58, v51, v50, 2
    v_alignbyte_b32 v59, v52, v51, 2
    v_alignbyte_b32 v60, v53, v52, 2
    ds_write_b128 v181, v[32:35] offset:8320
    v_pk_mov_b32 v[64:65], v[48:49], v[50:51] op_sel:[1,0]
    v_pk_mov_b32 v[66:67], v[50:51], v[52:53] op_sel:[1,0]
    v_pk_mov_b32 v[68:69], v[56:57], v[58:59] op_sel:[1,0]
    v_pk_mov_b32 v[70:71], v[58:59], v[60:61] op_sel:[1,0]
    ds_write_b128 v181, v[36:39] offset:12480
    s_mov_b64 exec, 0
    s_cmp_eq_u32 s3, 0
    s_cbranch_scc1 PG4
    s_cmp_eq_u32 s3, 1
    s_cbranch_scc1 PG5
    s_cmp_eq_u32 s3, 2
    s_cbranch_scc1 PG6
    s_cmp_eq_u32 s3, 3
    s_cbranch_scc1 PG7
WARM1_0_ret:
    s_mov_b64 exec, -1
    s_waitcnt lgkmcnt(0)
    s_barrier
    ds_read_b64 v[16:17], v6 offset:3776
    ds_read_b64 v[18:19], v6 offset:3784
    ds_read_b64 v[20:21], v6 offset:3264
    ds_read_b64 v[22:23], v6 offset:3272
    ds_read_b64 v[24:25], v6 offset:2752
    ds_read_b64 v[26:27], v6 offset:2760
    ds_read_b64 v[28:29], v6 offset:2240
    ds_read_b64 v[30:31], v6 offset:2248
    ds_read_b64 v[32:33], v6 offset:1728
    ds_read_b64 v[34:35], v6 offset:1736
    ds_read_b64 v[36:37], v6 offset:1216
    ds_read_b64 v[38:39], v6 offset:1224
    ds_read_b64 v[40:41], v6 offset:704
    ds_read_b64 v[42:43], v6 offset:712
    ds_read_b64 v[44:45], v6 offset:192
    ds_read_b64 v[46:47], v6 offset:200
    global_load_dword v255, v194, s[12:13] offset:2688
    buffer_load_dword v255, v167, s[16:19], 0 offen
    ds_write_b128 v181, v[56:59] offset:20800
    s_mov_b32 s6, 0
    s_waitcnt vmcnt(2)
A_poll:
    v_lshl_add_u32 v12, v229, 1, v228
    v_lshl_add_u32 v13, v233, 1, v232
    v_add3_u32 v14, v229, v230, v231
    v_add3_u32 v15, v233, v234, v235
    v_lshl_add_u32 v12, v230, 2, v12
    v_lshl_add_u32 v13, v234, 2, v13
    v_lshl_add_u32 v12, v231, 3, v12
    v_lshl_add_u32 v13, v235, 3, v13
    v_add3_u32 v12, v12, v14, s44
    v_add3_u32 v13, v13, v15, s44
    v_xor_b32 v12, v12, v236
    v_bitop3_b32 v12, v13, v237, v12 bitop3:0xbe
    v_bitop3_b32 v12, v215, s44, v12 bitop3:0xbe
    v_bitop3_b32 v12, v219, s44, v12 bitop3:0xbe
    v_bitop3_b32 v12, v223, s44, v12 bitop3:0xbe
    v_bitop3_b32 v12, v227, s44, v12 bitop3:0xbe
    v_cmpx_ne_u32 vcc, 0, v12
    s_cbranch_execz A_poll_done
    s_add_u32 s6, s6, 1
    s_cmp_gt_u32 s6, 1048576
    s_cbranch_scc1 A_poll_done
    global_load_dwordx4 v[228:231], v177, s[42:43] offset:-2048 sc1
    global_load_dwordx4 v[232:235], v177, s[42:43] offset:2048 sc1
    global_load_dword v236, v178, s[42:43] sc1
    global_load_dword v237, v179, s[42:43] sc1
    global_load_dwordx4 v[212:215], v175, s[42:43] offset:0 sc1
    global_load_dwordx4 v[216:219], v175, s[42:43] offset:16 sc1
    global_load_dwordx4 v[220:223], v176, s[42:43] offset:0 sc1
    global_load_dwordx4 v[224:227], v176, s[42:43] offset:16 sc1
    s_waitcnt vmcnt(0)
    s_branch A_poll
A_poll_done:
    s_mov_b64 exec, -1
    s_add_u32 m0, s58, 0
    s_nop 0
    buffer_load_dwordx4 v160, s[12:15], s20 offen offset:0 lds
    s_add_u32 m0, s58, 0
    s_nop 0
    buffer_load_dwordx4 v161, s[12:15], s20 offen offset:1024 lds
    s_add_u32 m0, s58, 0
    s_nop 0
    buffer_load_dwordx4 v162, s[12:15], s20 offen offset:2048 lds
    ds_write_b128 v181, v[64:67] offset:24960
    s_mov_b32 s4, 0x3f80
    s_mov_b32 s5, 0x3f800000
    v_lshlrev_b32 v84, 16, v214
    v_and_b32 v85, 0xffff0000, v214
    v_lshlrev_b32 v92, 16, v218
    v_and_b32 v93, 0xffff0000, v218
    v_dot2_f32_bf16 v80, v228, s4, v84
    v_dot2_f32_bf16 v81, v229, s4, v85
    v_dot2_f32_bf16 v82, v228, s5, v84
    v_dot2_f32_bf16 v83, v229, s5, v85
    v_dot2_f32_bf16 v88, v230, s4, v92
    v_dot2_f32_bf16 v89, v231, s4, v93
    v_dot2_f32_bf16 v90, v230, s5, v92
    v_dot2_f32_bf16 v91, v231, s5, v93
    ds_write_b128 v181, v[228:231] offset:42496
    v_cvt_pk_bf16_f32 v86, v80, v81
    v_cvt_pk_bf16_f32 v87, v82, v83
    v_cvt_pk_bf16_f32 v94, v88, v89
    v_cvt_pk_bf16_f32 v95, v90, v91
    v_lshlrev_b32 v80, 16, v86
    v_and_b32 v81, 0xffff0000, v86
    v_lshlrev_b32 v82, 16, v87
    v_and_b32 v83, 0xffff0000, v87
    v_lshlrev_b32 v88, 16, v94
    v_and_b32 v89, 0xffff0000, v94
    v_lshlrev_b32 v90, 16, v95
    v_and_b32 v91, 0xffff0000, v95
    ds_write_b128 v181, v[68:71] offset:29120
    v_pk_mul_f32 v[80:81], v[80:81], v[212:213]
    v_pk_mul_f32 v[82:83], v[82:83], v[212:213]
    v_pk_mul_f32 v[88:89], v[88:89], v[216:217]
    v_pk_mul_f32 v[90:91], v[90:91], v[216:217]
    v_cvt_pk_bf16_f32 v112, v80, v81
    v_cvt_pk_bf16_f32 v114, v82, v83
    v_cvt_pk_bf16_f32 v113, v88, v89
    v_cvt_pk_bf16_f32 v115, v90, v91
    ds_write2st64_b64 v184, v[112:113], v[114:115] offset0:0 offset1:9
    v_lshlrev_b32 v100, 16, v222
    v_and_b32 v101, 0xffff0000, v222
    v_lshlrev_b32 v108, 16, v226
    v_and_b32 v109, 0xffff0000, v226
    v_dot2_f32_bf16 v96, v232, s4, v100
    v_dot2_f32_bf16 v97, v233, s4, v101
    v_dot2_f32_bf16 v98, v232, s5, v100
    v_dot2_f32_bf16 v99, v233, s5, v101
    v_dot2_f32_bf16 v104, v234, s4, v108
    v_dot2_f32_bf16 v105, v235, s4, v109
    v_dot2_f32_bf16 v106, v234, s5, v108
    v_dot2_f32_bf16 v107, v235, s5, v109
    ds_write_b128 v181, v[232:235] offset:46592
    v_cvt_pk_bf16_f32 v102, v96, v97
    v_cvt_pk_bf16_f32 v103, v98, v99
    v_cvt_pk_bf16_f32 v110, v104, v105
    v_cvt_pk_bf16_f32 v111, v106, v107
    v_lshlrev_b32 v96, 16, v102
    v_and_b32 v97, 0xffff0000, v102
    v_lshlrev_b32 v98, 16, v103
    v_and_b32 v99, 0xffff0000, v103
    v_lshlrev_b32 v104, 16, v110
    v_and_b32 v105, 0xffff0000, v110
    v_lshlrev_b32 v106, 16, v111
    v_and_b32 v107, 0xffff0000, v111
    v_pk_mul_f32 v[96:97], v[96:97], v[220:221]
    v_pk_mul_f32 v[98:99], v[98:99], v[220:221]
    v_pk_mul_f32 v[104:105], v[104:105], v[224:225]
    v_pk_mul_f32 v[106:107], v[106:107], v[224:225]
    v_cvt_pk_bf16_f32 v116, v96, v97
    v_cvt_pk_bf16_f32 v118, v98, v99
    v_cvt_pk_bf16_f32 v117, v104, v105
    v_cvt_pk_bf16_f32 v119, v106, v107
    ds_write2st64_b64 v184, v[116:117], v[118:119] offset0:4 offset1:13
    global_load_dword v193, v193, s[42:43] sc1
    s_waitcnt lgkmcnt(0)
    s_barrier
    s_cmp_eq_u32 s50, 0
    s_cbranch_scc0 A_conv1
    ds_read_b128 v[76:79], v7 offset:3776
    ds_read_b128 v[72:75], v7 offset:3264
    ds_read_b128 v[68:71], v7 offset:2752
    ds_read_b128 v[64:67], v7 offset:2240
    ds_read_b128 v[60:63], v7 offset:1728
    ds_read_b128 v[56:59], v7 offset:1216
    ds_read_b128 v[52:55], v7 offset:704
    ds_read_b128 v[48:51], v7 offset:192
    s_waitcnt lgkmcnt(5)
    v_mfma_f32_16x16x32_bf16 v[144:147], v[16:19], v[76:79], 0
    ds_read_b64 v[80:81], v6 offset:3712
    ds_read_b64 v[82:83], v6 offset:3720
    v_mfma_f32_16x16x32_bf16 v[144:147], v[20:23], v[72:75], v[144:147]
    ds_read_b128 v[140:143], v7 offset:3712
    ds_read_b64 v[84:85], v6 offset:3200
    s_add_u32 m0, s58, 6144
    v_mfma_f32_16x16x32_bf16 v[144:147], v[24:27], v[68:71], v[144:147]
    ds_read_b64 v[86:87], v6 offset:3208
    buffer_load_dwordx4 v160, s[12:15], s21 offen offset:0 lds
    v_mfma_f32_16x16x32_bf16 v[148:151], v[16:19], v[68:71], 0
    ds_read_b128 v[136:139], v7 offset:3200
    ds_read_b64 v[88:89], v6 offset:2688
    s_waitcnt lgkmcnt(10)
    v_mfma_f32_16x16x32_bf16 v[144:147], v[28:31], v[64:67], v[144:147]
    ds_read_b64 v[90:91], v6 offset:2696
    v_mfma_f32_16x16x32_bf16 v[148:151], v[20:23], v[64:67], v[148:151]
    ds_read_b128 v[132:135], v7 offset:2688
    ds_read_b64 v[92:93], v6 offset:2176
    v_mfma_f32_16x16x32_bf16 v[144:147], v[32:35], v[60:63], v[144:147]
    ds_read_b64 v[94:95], v6 offset:2184
    v_mfma_f32_16x16x32_bf16 v[148:151], v[24:27], v[60:63], v[148:151]
    ds_read_b128 v[128:131], v7 offset:2176
    ds_read_b64 v[96:97], v6 offset:1664
    buffer_load_dwordx4 v161, s[12:15], s21 offen offset:1024 lds
    s_waitcnt lgkmcnt(14)
    v_mfma_f32_16x16x32_bf16 v[144:147], v[36:39], v[56:59], v[144:147]
    ds_read_b64 v[98:99], v6 offset:1672
    v_mfma_f32_16x16x32_bf16 v[148:151], v[28:31], v[56:59], v[148:151]
    ds_read_b128 v[124:127], v7 offset:1664
    ds_read_b64 v[100:101], v6 offset:1152
    v_mfma_f32_16x16x32_bf16 v[152:155], v[16:19], v[56:59], 0
    ds_read_b64 v[102:103], v6 offset:1160
    v_mfma_f32_16x16x32_bf16 v[144:147], v[40:43], v[52:55], v[144:147]
    ds_read_b128 v[120:123], v7 offset:1152
    ds_read_b64 v[104:105], v6 offset:640
    v_mfma_f32_16x16x32_bf16 v[148:151], v[32:35], v[52:55], v[148:151]
    ds_read_b64 v[106:107], v6 offset:648
    v_mfma_f32_16x16x32_bf16 v[152:155], v[20:23], v[52:55], v[152:155]
    ds_read_b128 v[116:119], v7 offset:640
    ds_read_b64 v[108:109], v6 offset:128
    buffer_load_dwordx4 v162, s[12:15], s21 offen offset:2048 lds
    s_waitcnt lgkmcnt(14)
    v_mfma_f32_16x16x32_bf16 v[144:147], v[44:47], v[48:51], v[144:147]
    ds_read_b64 v[110:111], v6 offset:136
    v_mfma_f32_16x16x32_bf16 v[148:151], v[36:39], v[48:51], v[148:151]
    ds_read_b128 v[112:115], v7 offset:128
    v_mfma_f32_16x16x32_bf16 v[152:155], v[24:27], v[48:51], v[152:155]
    ds_read_b64 v[168:169], v186 offset:1024
    ds_read_b64 v[170:171], v186 offset:0
    v_mfma_f32_16x16x32_bf16 v[156:159], v[16:19], v[48:51], 0
    v_mfma_f32_16x16x32_bf16 v[144:147], v[80:83], v[140:143], v[144:147]
    ds_read_b64 v[16:17], v6 offset:3648
    ds_read_b64 v[18:19], v6 offset:3656
    v_mfma_f32_16x16x32_bf16 v[144:147], v[84:87], v[136:139], v[144:147]
    ds_read_b128 v[76:79], v7 offset:3648
    ds_read_b64 v[20:21], v6 offset:3136
    s_add_u32 m0, s58, 12288
    s_waitcnt lgkmcnt(14)
    v_mfma_f32_16x16x32_bf16 v[144:147], v[88:91], v[132:135], v[144:147]
    ds_read_b64 v[22:23], v6 offset:3144
    buffer_load_dwordx4 v160, s[12:15], s22 offen offset:0 lds
    v_mfma_f32_16x16x32_bf16 v[148:151], v[80:83], v[132:135], v[148:151]
    ds_read_b128 v[72:75], v7 offset:3136
    ds_read_b64 v[24:25], v6 offset:2624
    v_mfma_f32_16x16x32_bf16 v[144:147], v[92:95], v[128:131], v[144:147]
    ds_read_b64 v[26:27], v6 offset:2632
    s_waitcnt lgkmcnt(8)
    v_lshlrev_b32 v228, 16, v168
    v_mfma_f32_16x16x32_bf16 v[148:151], v[84:87], v[128:131], v[148:151]
    ds_read_b128 v[68:71], v7 offset:2624
    ds_read_b64 v[28:29], v6 offset:2112
    v_mfma_f32_16x16x32_bf16 v[144:147], v[96:99], v[124:127], v[144:147]
    ds_read_b64 v[30:31], v6 offset:2120
    v_and_b32 v229, 0xffff0000, v168
    v_mfma_f32_16x16x32_bf16 v[148:151], v[88:91], v[124:127], v[148:151]
    ds_read_b128 v[64:67], v7 offset:2112
    ds_read_b64 v[32:33], v6 offset:1600
    buffer_load_dwordx4 v161, s[12:15], s22 offen offset:1024 lds
    v_mfma_f32_16x16x32_bf16 v[144:147], v[100:103], v[120:123], v[144:147]
    ds_read_b64 v[34:35], v6 offset:1608
    v_lshlrev_b32 v230, 16, v169
    v_mfma_f32_16x16x32_bf16 v[148:151], v[92:95], v[120:123], v[148:151]
    ds_read_b128 v[60:63], v7 offset:1600
    ds_read_b64 v[36:37], v6 offset:1088
    v_mfma_f32_16x16x32_bf16 v[152:155], v[80:83], v[120:123], v[152:155]
    ds_read_b64 v[38:39], v6 offset:1096
    v_and_b32 v231, 0xffff0000, v169
    v_mfma_f32_16x16x32_bf16 v[144:147], v[104:107], v[116:119], v[144:147]
    ds_read_b128 v[56:59], v7 offset:1088
    ds_read_b64 v[40:41], v6 offset:576
    v_mfma_f32_16x16x32_bf16 v[148:151], v[96:99], v[116:119], v[148:151]
    ds_read_b64 v[42:43], v6 offset:584
    v_lshlrev_b32 v232, 16, v170
    v_mfma_f32_16x16x32_bf16 v[152:155], v[84:87], v[116:119], v[152:155]
    ds_read_b128 v[52:55], v7 offset:576
    ds_read_b64 v[44:45], v6 offset:64
    buffer_load_dwordx4 v162, s[12:15], s22 offen offset:2048 lds
    v_mfma_f32_16x16x32_bf16 v[144:147], v[108:111], v[112:115], v[144:147]
    ds_read_b64 v[46:47], v6 offset:72
    v_and_b32 v233, 0xffff0000, v170
    v_mfma_f32_16x16x32_bf16 v[148:151], v[100:103], v[112:115], v[148:151]
    ds_read_b128 v[48:51], v7 offset:64
    v_mfma_f32_16x16x32_bf16 v[152:155], v[88:91], v[112:115], v[152:155]
    s_and_b32 s6, s53, 1
    s_mul_i32 s6, s6, 88064
    s_add_u32 s6, s6, s20
    s_add_u32 s6, s6, 2752
    s_mul_i32 s7, s49, 3072
    s_add_u32 m0, s7, 59392
    ds_read_b128 v[176:179], v187 offset:2048
    ds_read_b128 v[180:183], v187 offset:0
    v_lshlrev_b32 v234, 16, v171
    v_mfma_f32_16x16x32_bf16 v[156:159], v[80:83], v[112:115], v[156:159]
    buffer_load_dwordx4 v160, s[12:15], s6 offen offset:0 lds
    s_waitcnt lgkmcnt(14)
    v_mfma_f32_16x16x32_bf16 v[144:147], v[16:19], v[76:79], v[144:147]
    ds_read_b64 v[80:81], v6 offset:3584
    ds_read_b64 v[82:83], v6 offset:3592
    v_and_b32 v235, 0xffff0000, v171
    v_mfma_f32_16x16x32_bf16 v[144:147], v[20:23], v[72:75], v[144:147]
    ds_read_b128 v[140:143], v7 offset:3584
    ds_read_b64 v[84:85], v6 offset:3072
    s_add_u32 m0, s58, 18432
    v_mfma_f32_16x16x32_bf16 v[144:147], v[24:27], v[68:71], v[144:147]
    ds_read_b64 v[86:87], v6 offset:3080
    buffer_load_dwordx4 v160, s[12:15], s23 offen offset:0 lds
    v_pk_mul_f32 v[228:229], v[228:229], s[0:1] op_sel_hi:[1,0]
    v_pk_mul_f32 v[230:231], v[230:231], s[0:1] op_sel_hi:[1,0]
    v_pk_mul_f32 v[232:233], v[232:233], s[0:1] op_sel_hi:[1,0]
    v_pk_mul_f32 v[234:235], v[234:235], s[0:1] op_sel_hi:[1,0]
    v_mfma_f32_16x16x32_bf16 v[148:151], v[16:19], v[68:71], v[148:151]
    ds_read_b128 v[136:139], v7 offset:3072
    ds_read_b64 v[88:89], v6 offset:2560
    v_mfma_f32_16x16x32_bf16 v[144:147], v[28:31], v[64:67], v[144:147]
    ds_read_b64 v[90:91], v6 offset:2568
    v_cvt_pk_bf16_f32 v168, v228, v229
    v_mfma_f32_16x16x32_bf16 v[148:151], v[20:23], v[64:67], v[148:151]
    ds_read_b128 v[132:135], v7 offset:2560
    ds_read_b64 v[92:93], v6 offset:2048
    s_waitcnt lgkmcnt(14)
    v_mfma_f32_16x16x32_bf16 v[144:147], v[32:35], v[60:63], v[144:147]
    ds_read_b64 v[94:95], v6 offset:2056
    v_cvt_pk_bf16_f32 v169, v230, v231
    v_mfma_f32_16x16x32_bf16 v[148:151], v[24:27], v[60:63], v[148:151]
    ds_read_b128 v[128:131], v7 offset:2048
    ds_read_b64 v[96:97], v6 offset:1536
    buffer_load_dwordx4 v161, s[12:15], s23 offen offset:1024 lds
    v_mfma_f32_16x16x32_bf16 v[144:147], v[36:39], v[56:59], v[144:147]
    ds_read_b64 v[98:99], v6 offset:1544
    v_cvt_pk_bf16_f32 v170, v232, v233
    v_mfma_f32_16x16x32_bf16 v[148:151], v[28:31], v[56:59], v[148:151]
    ds_read_b128 v[124:127], v7 offset:1536
    ds_read_b64 v[100:101], v6 offset:1024
    v_mfma_f32_16x16x32_bf16 v[152:155], v[16:19], v[56:59], v[152:155]
    ds_read_b64 v[102:103], v6 offset:1032
    v_cvt_pk_bf16_f32 v171, v234, v235
    v_mfma_f32_16x16x32_bf16 v[144:147], v[40:43], v[52:55], v[144:147]
    ds_read_b128 v[120:123], v7 offset:1024
    ds_read_b64 v[104:105], v6 offset:512
    v_mfma_f32_16x16x32_bf16 v[148:151], v[32:35], v[52:55], v[148:151]
    ds_read_b64 v[106:107], v6 offset:520
    v_mfma_f32_16x16x32_bf16 v[152:155], v[20:23], v[52:55], v[152:155]
    ds_read_b128 v[116:119], v7 offset:512
    ds_read_b64 v[108:109], v6 offset:0
    buffer_load_dwordx4 v162, s[12:15], s23 offen offset:2048 lds
    s_waitcnt lgkmcnt(14)
    v_mfma_f32_16x16x32_bf16 v[144:147], v[44:47], v[48:51], v[144:147]
    ds_read_b64 v[110:111], v6 offset:8
    v_mfma_f32_16x16x32_bf16 v[148:151], v[36:39], v[48:51], v[148:151]
    ds_read_b128 v[112:115], v7 offset:0
    v_mfma_f32_16x16x32_bf16 v[152:155], v[24:27], v[48:51], v[152:155]
    s_add_u32 m0, s7, 59392
    ds_read_b64 v[172:173], v186 offset:5632
    ds_read_b64 v[174:175], v186 offset:4608
    v_mfma_f32_16x16x32_bf16 v[156:159], v[16:19], v[48:51], v[156:159]
    buffer_load_dwordx4 v161, s[12:15], s6 offen offset:1024 lds
    v_mfma_f32_16x16x32_bf16 v[144:147], v[80:83], v[140:143], v[144:147]
    ds_read_b64 v[16:17], v6 offset:20416
    ds_read_b64 v[18:19], v6 offset:20424
    v_lshlrev_b32 v244, 16, v168
    v_mfma_f32_16x16x32_bf16 v[144:147], v[84:87], v[136:139], v[144:147]
    ds_read_b128 v[76:79], v7 offset:8384
    ds_read_b64 v[20:21], v6 offset:19904
    s_add_u32 m0, s58, 24576
    v_and_b32 v245, 0xffff0000, v168
    s_waitcnt lgkmcnt(14)
    v_mfma_f32_16x16x32_bf16 v[144:147], v[88:91], v[132:135], v[144:147]
    ds_read_b64 v[22:23], v6 offset:19912
    buffer_load_dwordx4 v160, s[12:15], s24 offen offset:0 lds
    v_lshlrev_b32 v246, 16, v169
    v_mfma_f32_16x16x32_bf16 v[148:151], v[80:83], v[132:135], v[148:151]
    ds_read_b128 v[72:75], v7 offset:7872
    ds_read_b64 v[24:25], v6 offset:19392
    v_and_b32 v247, 0xffff0000, v169
    v_mfma_f32_16x16x32_bf16 v[144:147], v[92:95], v[128:131], v[144:147]
    ds_read_b64 v[26:27], v6 offset:19400
    v_lshlrev_b32 v248, 16, v170
    v_mfma_f32_16x16x32_bf16 v[148:151], v[84:87], v[128:131], v[148:151]
    ds_read_b128 v[68:71], v7 offset:7360
    ds_read_b64 v[28:29], v6 offset:18880
    v_and_b32 v249, 0xffff0000, v170
    v_mfma_f32_16x16x32_bf16 v[144:147], v[96:99], v[124:127], v[144:147]
    ds_read_b64 v[30:31], v6 offset:18888
    v_lshlrev_b32 v250, 16, v171
    v_mfma_f32_16x16x32_bf16 v[148:151], v[88:91], v[124:127], v[148:151]
    ds_read_b128 v[64:67], v7 offset:6848
    ds_read_b64 v[32:33], v6 offset:18368
    buffer_load_dwordx4 v161, s[12:15], s24 offen offset:1024 lds
    v_and_b32 v251, 0xffff0000, v171
    s_waitcnt lgkmcnt(14)
    v_mfma_f32_16x16x32_bf16 v[144:147], v[100:103], v[120:123], v[144:147]
    ds_read_b64 v[34:35], v6 offset:18376
    v_lshlrev_b32 v8, 16, v176
    v_mfma_f32_16x16x32_bf16 v[148:151], v[92:95], v[120:123], v[148:151]
    ds_read_b128 v[60:63], v7 offset:6336
    ds_read_b64 v[36:37], v6 offset:17856
    v_lshlrev_b32 v9, 16, v177
    v_mfma_f32_16x16x32_bf16 v[152:155], v[80:83], v[120:123], v[152:155]
    ds_read_b64 v[38:39], v6 offset:17864
    v_lshlrev_b32 v10, 16, v178
    v_mfma_f32_16x16x32_bf16 v[144:147], v[104:107], v[116:119], v[144:147]
    ds_read_b128 v[56:59], v7 offset:5824
    ds_read_b64 v[40:41], v6 offset:17344
    v_lshlrev_b32 v11, 16, v179
    v_mfma_f32_16x16x32_bf16 v[148:151], v[96:99], v[116:119], v[148:151]
    ds_read_b64 v[42:43], v6 offset:17352
    v_lshlrev_b32 v12, 16, v180
    v_mfma_f32_16x16x32_bf16 v[152:155], v[84:87], v[116:119], v[152:155]
    ds_read_b128 v[52:55], v7 offset:5312
    ds_read_b64 v[44:45], v6 offset:16832
    buffer_load_dwordx4 v162, s[12:15], s24 offen offset:2048 lds
    v_lshlrev_b32 v13, 16, v181
    v_mfma_f32_16x16x32_bf16 v[144:147], v[108:111], v[112:115], v[144:147]
    ds_read_b64 v[46:47], v6 offset:16840
    v_lshlrev_b32 v14, 16, v182
    v_mfma_f32_16x16x32_bf16 v[148:151], v[100:103], v[112:115], v[148:151]
    ds_read_b128 v[48:51], v7 offset:4800
    v_lshlrev_b32 v15, 16, v183
    v_mfma_f32_16x16x32_bf16 v[152:155], v[88:91], v[112:115], v[152:155]
    s_add_u32 m0, s7, 59392
    v_mfma_f32_16x16x32_bf16 v[156:159], v[80:83], v[112:115], v[156:159]
    buffer_load_dwordx4 v162, s[12:15], s6 offen offset:2048 lds
    s_waitcnt lgkmcnt(14)
    v_mfma_f32_16x16x32_bf16 v[196:199], v[16:19], v[76:79], 0
    ds_read_b64 v[80:81], v6 offset:20352
    ds_read_b64 v[82:83], v6 offset:20360
    v_mfma_f32_16x16x32_bf16 v[196:199], v[20:23], v[72:75], v[196:199]
    ds_read_b128 v[140:143], v7 offset:8320
    ds_read_b64 v[84:85], v6 offset:19840
    s_add_u32 m0, s58, 30720
    v_mfma_f32_16x16x32_bf16 v[196:199], v[24:27], v[68:71], v[196:199]
    buffer_load_dwordx4 v160, s[12:15], s25 offen offset:0 lds
    s_cmp_eq_u32 s49, 0
    s_cbranch_scc1 XS_a0
    v_swap_b32 v144, v152
    v_swap_b32 v145, v153
    v_swap_b32 v146, v154
    v_swap_b32 v147, v155
    v_swap_b32 v148, v156
    v_swap_b32 v149, v157
    v_swap_b32 v150, v158
    v_swap_b32 v151, v159
XS_a0:
    ds_write_b128 v195, v[152:155] offset:8704
    ds_write_b128 v195, v[156:159] offset:9728
    v_mfma_f32_16x16x32_bf16 v[200:203], v[16:19], v[68:71], 0
    s_waitcnt lgkmcnt(14)
    v_mfma_f32_16x16x32_bf16 v[196:199], v[28:31], v[64:67], v[196:199]
    v_mfma_f32_16x16x32_bf16 v[200:203], v[20:23], v[64:67], v[200:203]
    v_mfma_f32_16x16x32_bf16 v[196:199], v[32:35], v[60:63], v[196:199]
    ds_read_b64 v[86:87], v6 offset:19848
    ds_read_b128 v[136:139], v7 offset:7808
    s_waitcnt lgkmcnt(2)
    s_barrier
    ds_read_b128 v[212:215], v2 offset:8704
    ds_read_b128 v[216:219], v2 offset:9728
    v_mfma_f32_16x16x32_bf16 v[200:203], v[24:27], v[60:63], v[200:203]
    ds_read_b64 v[88:89], v6 offset:19328
    ds_read_b64 v[90:91], v6 offset:19336
    v_mfma_f32_16x16x32_bf16 v[196:199], v[36:39], v[56:59], v[196:199]
    ds_read_b128 v[132:135], v7 offset:7296
    ds_read_b64 v[92:93], v6 offset:18816
    v_mfma_f32_16x16x32_bf16 v[200:203], v[28:31], v[56:59], v[200:203]
    ds_read_b64 v[94:95], v6 offset:18824
    ds_read_b128 v[128:131], v7 offset:6784
    v_mfma_f32_16x16x32_bf16 v[204:207], v[16:19], v[56:59], 0
    ds_read_b64 v[96:97], v6 offset:18304
    ds_read_b64 v[98:99], v6 offset:18312
    v_mfma_f32_16x16x32_bf16 v[196:199], v[40:43], v[52:55], v[196:199]
    ds_read_b128 v[124:127], v7 offset:6272
    ds_read_b64 v[100:101], v6 offset:17792
    s_waitcnt lgkmcnt(10)
    v_pk_add_f32 v[212:213], v[212:213], v[144:145]
    v_pk_add_f32 v[214:215], v[214:215], v[146:147]
    v_pk_add_f32 v[216:217], v[216:217], v[148:149]
    v_pk_add_f32 v[218:219], v[218:219], v[150:151]
    v_cvt_pk_bf16_f32 v220, v212, v213
    v_cvt_pk_bf16_f32 v221, v214, v215
    v_cvt_pk_bf16_f32 v222, v216, v217
    v_cvt_pk_bf16_f32 v223, v218, v219
    v_mfma_f32_16x16x32_bf16 v[200:203], v[32:35], v[52:55], v[200:203]
    ds_read_b64 v[102:103], v6 offset:17800
    ds_read_b128 v[120:123], v7 offset:5760
    v_lshlrev_b32 v212, 16, v220
    v_and_b32 v213, 0xffff0000, v220
    v_lshlrev_b32 v214, 16, v221
    v_and_b32 v215, 0xffff0000, v221
    v_lshlrev_b32 v216, 16, v222
    v_and_b32 v217, 0xffff0000, v222
    v_mfma_f32_16x16x32_bf16 v[204:207], v[20:23], v[52:55], v[204:207]
    ds_read_b64 v[104:105], v6 offset:17280
    ds_read_b64 v[106:107], v6 offset:17288
    v_lshlrev_b32 v218, 16, v223
    v_and_b32 v219, 0xffff0000, v223
    v_pk_add_f32 v[212:213], v[212:213], v[244:245]
    v_pk_add_f32 v[214:215], v[214:215], v[246:247]
    v_pk_add_f32 v[216:217], v[216:217], v[248:249]
    v_pk_add_f32 v[218:219], v[218:219], v[250:251]
    v_cvt_pk_bf16_f32 v220, v212, v213
    v_cvt_pk_bf16_f32 v221, v214, v215
    v_cvt_pk_bf16_f32 v222, v216, v217
    v_mfma_f32_16x16x32_bf16 v[196:199], v[44:47], v[48:51], v[196:199]
    ds_read_b128 v[116:119], v7 offset:5248
    ds_read_b64 v[108:109], v6 offset:16768
    v_cvt_pk_bf16_f32 v223, v218, v219
    v_lshlrev_b32 v212, 16, v220
    v_and_b32 v213, 0xffff0000, v220
    v_lshlrev_b32 v214, 16, v221
    v_and_b32 v215, 0xffff0000, v221
    v_lshlrev_b32 v216, 16, v222
    v_mfma_f32_16x16x32_bf16 v[200:203], v[36:39], v[48:51], v[200:203]
    ds_read_b64 v[110:111], v6 offset:16776
    ds_read_b128 v[112:115], v7 offset:4736
    v_and_b32 v217, 0xffff0000, v222
    v_lshlrev_b32 v218, 16, v223
    v_and_b32 v219, 0xffff0000, v223
    v_pk_add_f32 v[212:213], v[212:213], v[8:9]
    v_pk_add_f32 v[214:215], v[214:215], v[10:11]
    v_pk_add_f32 v[216:217], v[216:217], v[12:13]
    v_pk_add_f32 v[218:219], v[218:219], v[14:15]
    v_cvt_pk_bf16_f32 v224, v212, v213
    v_cvt_pk_bf16_f32 v225, v214, v215
    v_mfma_f32_16x16x32_bf16 v[204:207], v[24:27], v[48:51], v[204:207]
    v_cvt_pk_bf16_f32 v226, v216, v217
    v_cvt_pk_bf16_f32 v227, v218, v219
    s_nop 0
    v_permlane16_swap_b32 v224, v226
    v_permlane16_swap_b32 v225, v227
    global_store_dwordx4 v188, v[224:227], s[42:43] sc1
    v_mfma_f32_16x16x32_bf16 v[208:211], v[16:19], v[48:51], 0
    v_mfma_f32_16x16x32_bf16 v[196:199], v[80:83], v[140:143], v[196:199]
    ds_read_b64 v[16:17], v6 offset:20288
    ds_read_b64 v[18:19], v6 offset:20296
    v_mfma_f32_16x16x32_bf16 v[196:199], v[84:87], v[136:139], v[196:199]
PG4:
    s_cbranch_execz WARM1_0_ret
    ds_read_b128 v[76:79], v7 offset:8256
    ds_read_b64 v[20:21], v6 offset:19776
    s_add_u32 m0, s58, 30720
    s_waitcnt lgkmcnt(14)
    v_mfma_f32_16x16x32_bf16 v[196:199], v[88:91], v[132:135], v[196:199]
    ds_read_b64 v[22:23], v6 offset:19784
    buffer_load_dwordx4 v161, s[12:15], s25 offen offset:1024 lds
    v_mfma_f32_16x16x32_bf16 v[200:203], v[80:83], v[132:135], v[200:203]
    ds_read_b128 v[72:75], v7 offset:7744
    ds_read_b64 v[24:25], v6 offset:19264
    v_mfma_f32_16x16x32_bf16 v[196:199], v[92:95], v[128:131], v[196:199]
    ds_read_b64 v[26:27], v6 offset:19272
    v_mfma_f32_16x16x32_bf16 v[200:203], v[84:87], v[128:131], v[200:203]
    ds_read_b128 v[68:71], v7 offset:7232
    ds_read_b64 v[28:29], v6 offset:18752
    s_waitcnt lgkmcnt(14)
    v_mfma_f32_16x16x32_bf16 v[196:199], v[96:99], v[124:127], v[196:199]
    ds_read_b64 v[30:31], v6 offset:18760
    v_mfma_f32_16x16x32_bf16 v[200:203], v[88:91], v[124:127], v[200:203]
    ds_read_b128 v[64:67], v7 offset:6720
    ds_read_b64 v[32:33], v6 offset:18240
    v_mfma_f32_16x16x32_bf16 v[196:199], v[100:103], v[120:123], v[196:199]
    ds_read_b64 v[34:35], v6 offset:18248
    buffer_load_dwordx4 v162, s[12:15], s25 offen offset:2048 lds
    v_mfma_f32_16x16x32_bf16 v[200:203], v[92:95], v[120:123], v[200:203]
    ds_read_b128 v[60:63], v7 offset:6208
    ds_read_b64 v[36:37], v6 offset:17728
    v_mfma_f32_16x16x32_bf16 v[204:207], v[80:83], v[120:123], v[204:207]
    ds_read_b64 v[38:39], v6 offset:17736
    s_waitcnt lgkmcnt(14)
    v_mfma_f32_16x16x32_bf16 v[196:199], v[104:107], v[116:119], v[196:199]
    ds_read_b128 v[56:59], v7 offset:5696
    ds_read_b64 v[40:41], v6 offset:17216
    v_mfma_f32_16x16x32_bf16 v[200:203], v[96:99], v[116:119], v[200:203]
    ds_read_b64 v[42:43], v6 offset:17224
    v_mfma_f32_16x16x32_bf16 v[204:207], v[84:87], v[116:119], v[204:207]
    ds_read_b128 v[52:55], v7 offset:5184
    ds_read_b64 v[44:45], v6 offset:16704
    v_mfma_f32_16x16x32_bf16 v[196:199], v[108:111], v[112:115], v[196:199]
    ds_read_b64 v[46:47], v6 offset:16712
    v_mfma_f32_16x16x32_bf16 v[200:203], v[100:103], v[112:115], v[200:203]
    ds_read_b128 v[48:51], v7 offset:4672
    buffer_load_dword v237, v252, s[16:19], 0 offen
    v_mfma_f32_16x16x32_bf16 v[204:207], v[88:91], v[112:115], v[204:207]
    v_mfma_f32_16x16x32_bf16 v[208:211], v[80:83], v[112:115], v[208:211]
    v_mfma_f32_16x16x32_bf16 v[196:199], v[16:19], v[76:79], v[196:199]
    ds_read_b64 v[80:81], v6 offset:20224
    ds_read_b64 v[82:83], v6 offset:20232
    s_waitcnt lgkmcnt(14)
    v_mfma_f32_16x16x32_bf16 v[196:199], v[20:23], v[72:75], v[196:199]
    ds_read_b128 v[140:143], v7 offset:8192
    ds_read_b64 v[84:85], v6 offset:19712
    s_add_u32 m0, s58, 36864
    v_mfma_f32_16x16x32_bf16 v[196:199], v[24:27], v[68:71], v[196:199]
    ds_read_b64 v[86:87], v6 offset:19720
    buffer_load_dwordx4 v160, s[12:15], s26 offen offset:0 lds
    v_mfma_f32_16x16x32_bf16 v[200:203], v[16:19], v[68:71], v[200:203]
    ds_read_b128 v[136:139], v7 offset:7680
    ds_read_b64 v[88:89], v6 offset:19200
    v_mfma_f32_16x16x32_bf16 v[196:199], v[28:31], v[64:67], v[196:199]
    ds_read_b64 v[90:91], v6 offset:19208
    v_mfma_f32_16x16x32_bf16 v[200:203], v[20:23], v[64:67], v[200:203]
    ds_read_b128 v[132:135], v7 offset:7168
    ds_read_b64 v[92:93], v6 offset:18688
    s_waitcnt lgkmcnt(14)
    v_mfma_f32_16x16x32_bf16 v[196:199], v[32:35], v[60:63], v[196:199]
    ds_read_b64 v[94:95], v6 offset:18696
    buffer_load_dwordx4 v161, s[12:15], s26 offen offset:1024 lds
    v_mfma_f32_16x16x32_bf16 v[200:203], v[24:27], v[60:63], v[200:203]
    ds_read_b128 v[128:131], v7 offset:6656
    ds_read_b64 v[96:97], v6 offset:18176
    v_mfma_f32_16x16x32_bf16 v[196:199], v[36:39], v[56:59], v[196:199]
    ds_read_b64 v[98:99], v6 offset:18184
    s_waitcnt vmcnt(5)
    s_mov_b32 exec_lo, s52
    s_mov_b32 exec_hi, 0
    global_store_dword v191, v192, s[42:43] sc1
    s_mov_b64 exec, -1
    v_mfma_f32_16x16x32_bf16 v[200:203], v[28:31], v[56:59], v[200:203]
    ds_read_b128 v[124:127], v7 offset:6144
    ds_read_b64 v[100:101], v6 offset:17664
    v_mfma_f32_16x16x32_bf16 v[204:207], v[16:19], v[56:59], v[204:207]
    ds_read_b64 v[102:103], v6 offset:17672
    buffer_load_dwordx4 v162, s[12:15], s26 offen offset:2048 lds
    s_waitcnt lgkmcnt(14)
    v_mfma_f32_16x16x32_bf16 v[196:199], v[40:43], v[52:55], v[196:199]
    ds_read_b128 v[120:123], v7 offset:5632
    ds_read_b64 v[104:105], v6 offset:17152
    v_mfma_f32_16x16x32_bf16 v[200:203], v[32:35], v[52:55], v[200:203]
    ds_read_b64 v[106:107], v6 offset:17160
    v_mfma_f32_16x16x32_bf16 v[204:207], v[20:23], v[52:55], v[204:207]
    ds_read_b128 v[116:119], v7 offset:5120
    ds_read_b64 v[108:109], v6 offset:16640
    v_mfma_f32_16x16x32_bf16 v[196:199], v[44:47], v[48:51], v[196:199]
    ds_read_b64 v[110:111], v6 offset:16648
    v_mfma_f32_16x16x32_bf16 v[200:203], v[36:39], v[48:51], v[200:203]
    ds_read_b128 v[112:115], v7 offset:4608
    v_mfma_f32_16x16x32_bf16 v[204:207], v[24:27], v[48:51], v[204:207]
    v_lshlrev_b32 v228, 16, v172
    v_and_b32 v229, 0xffff0000, v172
    v_mfma_f32_16x16x32_bf16 v[208:211], v[16:19], v[48:51], v[208:211]
    v_lshlrev_b32 v230, 16, v173
    v_and_b32 v231, 0xffff0000, v173
    v_mfma_f32_16x16x32_bf16 v[196:199], v[80:83], v[140:143], v[196:199]
    v_lshlrev_b32 v232, 16, v174
    v_and_b32 v233, 0xffff0000, v174
    s_waitcnt lgkmcnt(12)
    v_mfma_f32_16x16x32_bf16 v[196:199], v[84:87], v[136:139], v[196:199]
    s_add_u32 m0, s58, 43008
    v_lshlrev_b32 v234, 16, v175
    v_and_b32 v235, 0xffff0000, v175
    v_mfma_f32_16x16x32_bf16 v[196:199], v[88:91], v[132:135], v[196:199]
    buffer_load_dwordx4 v160, s[12:15], s27 offen offset:0 lds
    v_mul_f32 v228, s40, v228
    v_mul_f32 v229, s40, v229
    v_mfma_f32_16x16x32_bf16 v[200:203], v[80:83], v[132:135], v[200:203]
    v_mul_f32 v230, s40, v230
    v_mul_f32 v231, s40, v231
    v_mfma_f32_16x16x32_bf16 v[196:199], v[92:95], v[128:131], v[196:199]
    v_mul_f32 v232, s40, v232
    v_mul_f32 v233, s40, v233
    v_mfma_f32_16x16x32_bf16 v[200:203], v[84:87], v[128:131], v[200:203]
    v_mul_f32 v234, s40, v234
    v_mul_f32 v235, s40, v235
    s_waitcnt lgkmcnt(6)
    v_mfma_f32_16x16x32_bf16 v[196:199], v[96:99], v[124:127], v[196:199]
    buffer_load_dwordx4 v161, s[12:15], s27 offen offset:1024 lds
    v_cvt_pk_bf16_f32 v172, v228, v229
    v_cvt_pk_bf16_f32 v173, v230, v231
    v_mfma_f32_16x16x32_bf16 v[200:203], v[88:91], v[124:127], v[200:203]
    v_cvt_pk_bf16_f32 v174, v232, v233
    v_cvt_pk_bf16_f32 v175, v234, v235
    v_mfma_f32_16x16x32_bf16 v[196:199], v[100:103], v[120:123], v[196:199]
    v_lshlrev_b32 v244, 16, v172
    v_and_b32 v245, 0xffff0000, v172
    v_mfma_f32_16x16x32_bf16 v[200:203], v[92:95], v[120:123], v[200:203]
    v_lshlrev_b32 v246, 16, v173
    v_and_b32 v247, 0xffff0000, v173
    v_mfma_f32_16x16x32_bf16 v[204:207], v[80:83], v[120:123], v[204:207]
    buffer_load_dwordx4 v162, s[12:15], s27 offen offset:2048 lds
    v_lshlrev_b32 v248, 16, v174
    v_and_b32 v249, 0xffff0000, v174
    s_waitcnt lgkmcnt(0)
    v_mfma_f32_16x16x32_bf16 v[196:199], v[104:107], v[116:119], v[196:199]
    v_lshlrev_b32 v250, 16, v175
    v_and_b32 v251, 0xffff0000, v175
    v_mfma_f32_16x16x32_bf16 v[200:203], v[96:99], v[116:119], v[200:203]
    v_and_b32 v8, 0xffff0000, v176
    v_and_b32 v9, 0xffff0000, v177
    v_mfma_f32_16x16x32_bf16 v[204:207], v[84:87], v[116:119], v[204:207]
    v_and_b32 v10, 0xffff0000, v178
    v_and_b32 v11, 0xffff0000, v179
    v_mfma_f32_16x16x32_bf16 v[196:199], v[108:111], v[112:115], v[196:199]
    v_and_b32 v12, 0xffff0000, v180
    v_and_b32 v13, 0xffff0000, v181
    v_mfma_f32_16x16x32_bf16 v[200:203], v[100:103], v[112:115], v[200:203]
    v_and_b32 v14, 0xffff0000, v182
    v_and_b32 v15, 0xffff0000, v183
    v_mfma_f32_16x16x32_bf16 v[204:207], v[88:91], v[112:115], v[204:207]
    v_mfma_f32_16x16x32_bf16 v[208:211], v[80:83], v[112:115], v[208:211]
    s_cmp_eq_u32 s49, 0
    s_nop 4
    s_cbranch_scc1 XS_a1
    s_nop 4
    v_swap_b32 v196, v204
    v_swap_b32 v197, v205
    v_swap_b32 v198, v206
    v_swap_b32 v199, v207
    v_swap_b32 v200, v208
    v_swap_b32 v201, v209
    v_swap_b32 v202, v210
    v_swap_b32 v203, v211
XS_a1:
    ds_write_b128 v195, v[204:207] offset:0
    ds_write_b128 v195, v[208:211] offset:1024
    s_waitcnt lgkmcnt(0)
    s_barrier
    s_branch A_conv_done
A_conv1:
PG5:
    s_cbranch_execz WARM1_0_ret
    ds_read_b128 v[72:75], v7 offset:3264
    ds_read_b128 v[68:71], v7 offset:2752
    ds_read_b128 v[64:67], v7 offset:2240
    ds_read_b128 v[60:63], v7 offset:1728
    ds_read_b128 v[56:59], v7 offset:1216
    ds_read_b128 v[52:55], v7 offset:704
    ds_read_b128 v[48:51], v7 offset:192
    s_waitcnt lgkmcnt(4)
    v_mfma_f32_16x16x32_bf16 v[144:147], v[16:19], v[72:75], 0
    ds_read_b64 v[80:81], v6 offset:3712
    ds_read_b64 v[82:83], v6 offset:3720
    v_mfma_f32_16x16x32_bf16 v[144:147], v[20:23], v[68:71], v[144:147]
    ds_read_b128 v[136:139], v7 offset:3200
    s_add_u32 m0, s58, 6144
    v_mfma_f32_16x16x32_bf16 v[144:147], v[24:27], v[64:67], v[144:147]
    ds_read_b64 v[84:85], v6 offset:3200
    buffer_load_dwordx4 v160, s[12:15], s21 offen offset:0 lds
    v_mfma_f32_16x16x32_bf16 v[148:151], v[16:19], v[64:67], 0
    ds_read_b64 v[86:87], v6 offset:3208
    ds_read_b128 v[132:135], v7 offset:2688
    s_waitcnt lgkmcnt(8)
    v_mfma_f32_16x16x32_bf16 v[144:147], v[28:31], v[60:63], v[144:147]
    ds_read_b64 v[88:89], v6 offset:2688
    v_mfma_f32_16x16x32_bf16 v[148:151], v[20:23], v[60:63], v[148:151]
    ds_read_b64 v[90:91], v6 offset:2696
    v_mfma_f32_16x16x32_bf16 v[152:155], v[16:19], v[60:63], 0
    ds_read_b128 v[128:131], v7 offset:2176
    ds_read_b64 v[92:93], v6 offset:2176
    v_mfma_f32_16x16x32_bf16 v[144:147], v[32:35], v[56:59], v[144:147]
    ds_read_b64 v[94:95], v6 offset:2184
    buffer_load_dwordx4 v161, s[12:15], s21 offen offset:1024 lds
    v_mfma_f32_16x16x32_bf16 v[148:151], v[24:27], v[56:59], v[148:151]
    ds_read_b128 v[124:127], v7 offset:1664
    v_mfma_f32_16x16x32_bf16 v[152:155], v[20:23], v[56:59], v[152:155]
    ds_read_b64 v[96:97], v6 offset:1664
    ds_read_b64 v[98:99], v6 offset:1672
    s_waitcnt lgkmcnt(14)
    v_mfma_f32_16x16x32_bf16 v[144:147], v[36:39], v[52:55], v[144:147]
    ds_read_b128 v[120:123], v7 offset:1152
    v_mfma_f32_16x16x32_bf16 v[148:151], v[28:31], v[52:55], v[148:151]
    ds_read_b64 v[100:101], v6 offset:1152
    v_mfma_f32_16x16x32_bf16 v[152:155], v[24:27], v[52:55], v[152:155]
    ds_read_b64 v[102:103], v6 offset:1160
    ds_read_b128 v[116:119], v7 offset:640
    v_mfma_f32_16x16x32_bf16 v[156:159], v[16:19], v[52:55], 0
    ds_read_b64 v[104:105], v6 offset:640
    buffer_load_dwordx4 v162, s[12:15], s21 offen offset:2048 lds
    v_mfma_f32_16x16x32_bf16 v[144:147], v[40:43], v[48:51], v[144:147]
    ds_read_b64 v[106:107], v6 offset:648
    v_mfma_f32_16x16x32_bf16 v[148:151], v[32:35], v[48:51], v[148:151]
    ds_read_b128 v[112:115], v7 offset:128
    v_mfma_f32_16x16x32_bf16 v[152:155], v[28:31], v[48:51], v[152:155]
    ds_read_b64 v[168:169], v186 offset:1024
    ds_read_b64 v[170:171], v186 offset:0
    v_mfma_f32_16x16x32_bf16 v[156:159], v[20:23], v[48:51], v[156:159]
    s_waitcnt lgkmcnt(14)
    v_mfma_f32_16x16x32_bf16 v[144:147], v[80:83], v[136:139], v[144:147]
    ds_read_b64 v[16:17], v6 offset:3648
    ds_read_b64 v[18:19], v6 offset:3656
    v_mfma_f32_16x16x32_bf16 v[144:147], v[84:87], v[132:135], v[144:147]
    ds_read_b128 v[72:75], v7 offset:3136
    s_add_u32 m0, s58, 12288
    v_mfma_f32_16x16x32_bf16 v[144:147], v[88:91], v[128:131], v[144:147]
    ds_read_b64 v[20:21], v6 offset:3136
    buffer_load_dwordx4 v160, s[12:15], s22 offen offset:0 lds
    v_mfma_f32_16x16x32_bf16 v[148:151], v[80:83], v[128:131], v[148:151]
    ds_read_b64 v[22:23], v6 offset:3144
    ds_read_b128 v[68:71], v7 offset:2624
    s_waitcnt lgkmcnt(14)
    v_mfma_f32_16x16x32_bf16 v[144:147], v[92:95], v[124:127], v[144:147]
    ds_read_b64 v[24:25], v6 offset:2624
    s_waitcnt lgkmcnt(7)
    v_lshlrev_b32 v228, 16, v168
    v_mfma_f32_16x16x32_bf16 v[148:151], v[84:87], v[124:127], v[148:151]
    ds_read_b64 v[26:27], v6 offset:2632
    v_mfma_f32_16x16x32_bf16 v[152:155], v[80:83], v[124:127], v[152:155]
    ds_read_b128 v[64:67], v7 offset:2112
    ds_read_b64 v[28:29], v6 offset:2112
    v_and_b32 v229, 0xffff0000, v168
    v_mfma_f32_16x16x32_bf16 v[144:147], v[96:99], v[120:123], v[144:147]
    ds_read_b64 v[30:31], v6 offset:2120
    buffer_load_dwordx4 v161, s[12:15], s22 offen offset:1024 lds
    v_mfma_f32_16x16x32_bf16 v[148:151], v[88:91], v[120:123], v[148:151]
    ds_read_b128 v[60:63], v7 offset:1600
    v_lshlrev_b32 v230, 16, v169
    v_mfma_f32_16x16x32_bf16 v[152:155], v[84:87], v[120:123], v[152:155]
    ds_read_b64 v[32:33], v6 offset:1600
    ds_read_b64 v[34:35], v6 offset:1608
    v_mfma_f32_16x16x32_bf16 v[144:147], v[100:103], v[116:119], v[144:147]
    ds_read_b128 v[56:59], v7 offset:1088
    v_and_b32 v231, 0xffff0000, v169
    v_mfma_f32_16x16x32_bf16 v[148:151], v[92:95], v[116:119], v[148:151]
    ds_read_b64 v[36:37], v6 offset:1088
    v_mfma_f32_16x16x32_bf16 v[152:155], v[88:91], v[116:119], v[152:155]
    ds_read_b64 v[38:39], v6 offset:1096
    ds_read_b128 v[52:55], v7 offset:576
    v_lshlrev_b32 v232, 16, v170
    v_mfma_f32_16x16x32_bf16 v[156:159], v[80:83], v[116:119], v[156:159]
    ds_read_b64 v[40:41], v6 offset:576
    buffer_load_dwordx4 v162, s[12:15], s22 offen offset:2048 lds
    v_mfma_f32_16x16x32_bf16 v[144:147], v[104:107], v[112:115], v[144:147]
    ds_read_b64 v[42:43], v6 offset:584
    v_and_b32 v233, 0xffff0000, v170
    v_mfma_f32_16x16x32_bf16 v[148:151], v[96:99], v[112:115], v[148:151]
    ds_read_b128 v[48:51], v7 offset:64
    v_mfma_f32_16x16x32_bf16 v[152:155], v[92:95], v[112:115], v[152:155]
    ds_read_b128 v[176:179], v187 offset:2048
    ds_read_b128 v[180:183], v187 offset:0
    v_lshlrev_b32 v234, 16, v171
    v_mfma_f32_16x16x32_bf16 v[156:159], v[84:87], v[112:115], v[156:159]
    s_waitcnt lgkmcnt(14)
    v_mfma_f32_16x16x32_bf16 v[144:147], v[16:19], v[72:75], v[144:147]
    ds_read_b64 v[80:81], v6 offset:3584
    ds_read_b64 v[82:83], v6 offset:3592
    v_and_b32 v235, 0xffff0000, v171
    v_mfma_f32_16x16x32_bf16 v[144:147], v[20:23], v[68:71], v[144:147]
    ds_read_b128 v[136:139], v7 offset:3072
    s_add_u32 m0, s58, 18432
    v_mfma_f32_16x16x32_bf16 v[144:147], v[24:27], v[64:67], v[144:147]
    ds_read_b64 v[84:85], v6 offset:3072
    buffer_load_dwordx4 v160, s[12:15], s23 offen offset:0 lds
    v_pk_mul_f32 v[228:229], v[228:229], s[0:1] op_sel_hi:[1,0]
    v_pk_mul_f32 v[230:231], v[230:231], s[0:1] op_sel_hi:[1,0]
    v_pk_mul_f32 v[232:233], v[232:233], s[0:1] op_sel_hi:[1,0]
    v_pk_mul_f32 v[234:235], v[234:235], s[0:1] op_sel_hi:[1,0]
    v_mfma_f32_16x16x32_bf16 v[148:151], v[16:19], v[64:67], v[148:151]
    ds_read_b64 v[86:87], v6 offset:3080
    ds_read_b128 v[132:135], v7 offset:2560
    s_waitcnt lgkmcnt(14)
    v_mfma_f32_16x16x32_bf16 v[144:147], v[28:31], v[60:63], v[144:147]
    ds_read_b64 v[88:89], v6 offset:2560
    v_cvt_pk_bf16_f32 v168, v228, v229
    v_mfma_f32_16x16x32_bf16 v[148:151], v[20:23], v[60:63], v[148:151]
    ds_read_b64 v[90:91], v6 offset:2568
    v_mfma_f32_16x16x32_bf16 v[152:155], v[16:19], v[60:63], v[152:155]
    ds_read_b128 v[128:131], v7 offset:2048
    ds_read_b64 v[92:93], v6 offset:2048
    v_cvt_pk_bf16_f32 v169, v230, v231
    v_mfma_f32_16x16x32_bf16 v[144:147], v[32:35], v[56:59], v[144:147]
    ds_read_b64 v[94:95], v6 offset:2056
    buffer_load_dwordx4 v161, s[12:15], s23 offen offset:1024 lds
    v_mfma_f32_16x16x32_bf16 v[148:151], v[24:27], v[56:59], v[148:151]
    ds_read_b128 v[124:127], v7 offset:1536
    v_cvt_pk_bf16_f32 v170, v232, v233
    v_mfma_f32_16x16x32_bf16 v[152:155], v[20:23], v[56:59], v[152:155]
    ds_read_b64 v[96:97], v6 offset:1536
    ds_read_b64 v[98:99], v6 offset:1544
    s_waitcnt lgkmcnt(14)
    v_mfma_f32_16x16x32_bf16 v[144:147], v[36:39], v[52:55], v[144:147]
    ds_read_b128 v[120:123], v7 offset:1024
    v_cvt_pk_bf16_f32 v171, v234, v235
    v_mfma_f32_16x16x32_bf16 v[148:151], v[28:31], v[52:55], v[148:151]
    ds_read_b64 v[100:101], v6 offset:1024
    v_mfma_f32_16x16x32_bf16 v[152:155], v[24:27], v[52:55], v[152:155]
    ds_read_b64 v[102:103], v6 offset:1032
    ds_read_b128 v[116:119], v7 offset:512
    v_mfma_f32_16x16x32_bf16 v[156:159], v[16:19], v[52:55], v[156:159]
    ds_read_b64 v[104:105], v6 offset:512
    buffer_load_dwordx4 v162, s[12:15], s23 offen offset:2048 lds
    v_mfma_f32_16x16x32_bf16 v[144:147], v[40:43], v[48:51], v[144:147]
    ds_read_b64 v[106:107], v6 offset:520
    v_mfma_f32_16x16x32_bf16 v[148:151], v[32:35], v[48:51], v[148:151]
    ds_read_b128 v[112:115], v7 offset:0
    v_mfma_f32_16x16x32_bf16 v[152:155], v[28:31], v[48:51], v[152:155]
    ds_read_b64 v[172:173], v186 offset:5632
    ds_read_b64 v[174:175], v186 offset:4608
    v_mfma_f32_16x16x32_bf16 v[156:159], v[20:23], v[48:51], v[156:159]
    s_waitcnt lgkmcnt(14)
    v_mfma_f32_16x16x32_bf16 v[144:147], v[80:83], v[136:139], v[144:147]
    ds_read_b64 v[16:17], v6 offset:20416
    ds_read_b64 v[18:19], v6 offset:20424
    v_lshlrev_b32 v244, 16, v168
    v_mfma_f32_16x16x32_bf16 v[144:147], v[84:87], v[132:135], v[144:147]
    ds_read_b128 v[72:75], v7 offset:7872
    s_add_u32 m0, s58, 24576
    v_and_b32 v245, 0xffff0000, v168
    v_mfma_f32_16x16x32_bf16 v[144:147], v[88:91], v[128:131], v[144:147]
    ds_read_b64 v[20:21], v6 offset:19904
    buffer_load_dwordx4 v160, s[12:15], s24 offen offset:0 lds
    v_lshlrev_b32 v246, 16, v169
    v_mfma_f32_16x16x32_bf16 v[148:151], v[80:83], v[128:131], v[148:151]
    ds_read_b64 v[22:23], v6 offset:19912
    ds_read_b128 v[68:71], v7 offset:7360
    v_and_b32 v247, 0xffff0000, v169
    s_waitcnt lgkmcnt(14)
    v_mfma_f32_16x16x32_bf16 v[144:147], v[92:95], v[124:127], v[144:147]
    ds_read_b64 v[24:25], v6 offset:19392
    v_lshlrev_b32 v248, 16, v170
    v_mfma_f32_16x16x32_bf16 v[148:151], v[84:87], v[124:127], v[148:151]
    ds_read_b64 v[26:27], v6 offset:19400
    v_and_b32 v249, 0xffff0000, v170
    v_mfma_f32_16x16x32_bf16 v[152:155], v[80:83], v[124:127], v[152:155]
    ds_read_b128 v[64:67], v7 offset:6848
    ds_read_b64 v[28:29], v6 offset:18880
    v_lshlrev_b32 v250, 16, v171
    v_mfma_f32_16x16x32_bf16 v[144:147], v[96:99], v[120:123], v[144:147]
    ds_read_b64 v[30:31], v6 offset:18888
    buffer_load_dwordx4 v161, s[12:15], s24 offen offset:1024 lds
    v_and_b32 v251, 0xffff0000, v171
    v_mfma_f32_16x16x32_bf16 v[148:151], v[88:91], v[120:123], v[148:151]
    ds_read_b128 v[60:63], v7 offset:6336
    v_lshlrev_b32 v8, 16, v176
    v_mfma_f32_16x16x32_bf16 v[152:155], v[84:87], v[120:123], v[152:155]
    ds_read_b64 v[32:33], v6 offset:18368
    ds_read_b64 v[34:35], v6 offset:18376
    v_lshlrev_b32 v9, 16, v177
    s_waitcnt lgkmcnt(14)
    v_mfma_f32_16x16x32_bf16 v[144:147], v[100:103], v[116:119], v[144:147]
    ds_read_b128 v[56:59], v7 offset:5824
    v_lshlrev_b32 v10, 16, v178
    v_mfma_f32_16x16x32_bf16 v[148:151], v[92:95], v[116:119], v[148:151]
    ds_read_b64 v[36:37], v6 offset:17856
    v_lshlrev_b32 v11, 16, v179
    v_mfma_f32_16x16x32_bf16 v[152:155], v[88:91], v[116:119], v[152:155]
    ds_read_b64 v[38:39], v6 offset:17864
    ds_read_b128 v[52:55], v7 offset:5312
    v_lshlrev_b32 v12, 16, v180
    v_mfma_f32_16x16x32_bf16 v[156:159], v[80:83], v[116:119], v[156:159]
    ds_read_b64 v[40:41], v6 offset:17344
    buffer_load_dwordx4 v162, s[12:15], s24 offen offset:2048 lds
    v_lshlrev_b32 v13, 16, v181
    v_mfma_f32_16x16x32_bf16 v[144:147], v[104:107], v[112:115], v[144:147]
    ds_read_b64 v[42:43], v6 offset:17352
    v_lshlrev_b32 v14, 16, v182
    v_mfma_f32_16x16x32_bf16 v[148:151], v[96:99], v[112:115], v[148:151]
    ds_read_b128 v[48:51], v7 offset:4800
    v_lshlrev_b32 v15, 16, v183
    v_mfma_f32_16x16x32_bf16 v[152:155], v[92:95], v[112:115], v[152:155]
    v_mfma_f32_16x16x32_bf16 v[156:159], v[84:87], v[112:115], v[156:159]
    s_waitcnt lgkmcnt(12)
    v_mfma_f32_16x16x32_bf16 v[196:199], v[16:19], v[72:75], 0
    ds_read_b64 v[80:81], v6 offset:20352
    ds_read_b64 v[82:83], v6 offset:20360
    v_mfma_f32_16x16x32_bf16 v[196:199], v[20:23], v[68:71], v[196:199]
    ds_read_b128 v[136:139], v7 offset:7808
    ds_read_b64 v[84:85], v6 offset:19840
    s_add_u32 m0, s58, 30720
    v_mfma_f32_16x16x32_bf16 v[196:199], v[24:27], v[64:67], v[196:199]
    buffer_load_dwordx4 v160, s[12:15], s25 offen offset:0 lds
    s_cmp_eq_u32 s49, 0
    s_cbranch_scc1 XS_b0
    v_swap_b32 v144, v152
    v_swap_b32 v145, v153
    v_swap_b32 v146, v154
    v_swap_b32 v147, v155
    v_swap_b32 v148, v156
    v_swap_b32 v149, v157
    v_swap_b32 v150, v158
    v_swap_b32 v151, v159
XS_b0:
    ds_write_b128 v195, v[152:155] offset:8704
    ds_write_b128 v195, v[156:159] offset:9728
    v_mfma_f32_16x16x32_bf16 v[200:203], v[16:19], v[64:67], 0
    s_waitcnt lgkmcnt(12)
    v_mfma_f32_16x16x32_bf16 v[196:199], v[28:31], v[60:63], v[196:199]
    v_mfma_f32_16x16x32_bf16 v[200:203], v[20:23], v[60:63], v[200:203]
    v_mfma_f32_16x16x32_bf16 v[204:207], v[16:19], v[60:63], 0
    ds_read_b64 v[86:87], v6 offset:19848
    ds_read_b128 v[132:135], v7 offset:7296
    s_waitcnt lgkmcnt(2)
    s_barrier
    ds_read_b128 v[212:215], v2 offset:8704
    ds_read_b128 v[216:219], v2 offset:9728
    v_mfma_f32_16x16x32_bf16 v[196:199], v[32:35], v[56:59], v[196:199]
    ds_read_b64 v[88:89], v6 offset:19328
    ds_read_b64 v[90:91], v6 offset:19336
    v_mfma_f32_16x16x32_bf16 v[200:203], v[24:27], v[56:59], v[200:203]
    ds_read_b128 v[128:131], v7 offset:6784
    ds_read_b64 v[92:93], v6 offset:18816
    v_mfma_f32_16x16x32_bf16 v[204:207], v[20:23], v[56:59], v[204:207]
    ds_read_b64 v[94:95], v6 offset:18824
    ds_read_b128 v[124:127], v7 offset:6272
    v_mfma_f32_16x16x32_bf16 v[196:199], v[36:39], v[52:55], v[196:199]
    ds_read_b64 v[96:97], v6 offset:18304
    ds_read_b64 v[98:99], v6 offset:18312
    v_mfma_f32_16x16x32_bf16 v[200:203], v[28:31], v[52:55], v[200:203]
    ds_read_b128 v[120:123], v7 offset:5760
    ds_read_b64 v[100:101], v6 offset:17792
    s_waitcnt lgkmcnt(10)
    v_pk_add_f32 v[212:213], v[212:213], v[144:145]
    v_pk_add_f32 v[214:215], v[214:215], v[146:147]
    v_pk_add_f32 v[216:217], v[216:217], v[148:149]
    v_pk_add_f32 v[218:219], v[218:219], v[150:151]
    v_cvt_pk_bf16_f32 v220, v212, v213
    v_cvt_pk_bf16_f32 v221, v214, v215
    v_cvt_pk_bf16_f32 v222, v216, v217
    v_cvt_pk_bf16_f32 v223, v218, v219
    v_mfma_f32_16x16x32_bf16 v[204:207], v[24:27], v[52:55], v[204:207]
    ds_read_b64 v[102:103], v6 offset:17800
    ds_read_b128 v[116:119], v7 offset:5248
    v_lshlrev_b32 v212, 16, v220
    v_and_b32 v213, 0xffff0000, v220
    v_lshlrev_b32 v214, 16, v221
    v_and_b32 v215, 0xffff0000, v221
    v_lshlrev_b32 v216, 16, v222
    v_and_b32 v217, 0xffff0000, v222
    v_mfma_f32_16x16x32_bf16 v[208:211], v[16:19], v[52:55], 0
    ds_read_b64 v[104:105], v6 offset:17280
    ds_read_b64 v[106:107], v6 offset:17288
    v_lshlrev_b32 v218, 16, v223
    v_and_b32 v219, 0xffff0000, v223
    v_pk_add_f32 v[212:213], v[212:213], v[244:245]
    v_pk_add_f32 v[214:215], v[214:215], v[246:247]
    v_pk_add_f32 v[216:217], v[216:217], v[248:249]
    v_pk_add_f32 v[218:219], v[218:219], v[250:251]
    v_cvt_pk_bf16_f32 v220, v212, v213
    v_cvt_pk_bf16_f32 v221, v214, v215
    v_cvt_pk_bf16_f32 v222, v216, v217
    v_mfma_f32_16x16x32_bf16 v[196:199], v[40:43], v[48:51], v[196:199]
    ds_read_b128 v[112:115], v7 offset:4736
    v_cvt_pk_bf16_f32 v223, v218, v219
    v_lshlrev_b32 v212, 16, v220
    v_and_b32 v213, 0xffff0000, v220
    v_lshlrev_b32 v214, 16, v221
    v_and_b32 v215, 0xffff0000, v221
    v_lshlrev_b32 v216, 16, v222
    v_mfma_f32_16x16x32_bf16 v[200:203], v[32:35], v[48:51], v[200:203]
    v_and_b32 v217, 0xffff0000, v222
    v_lshlrev_b32 v218, 16, v223
    v_and_b32 v219, 0xffff0000, v223
    v_pk_add_f32 v[212:213], v[212:213], v[8:9]
    v_pk_add_f32 v[214:215], v[214:215], v[10:11]
    v_pk_add_f32 v[216:217], v[216:217], v[12:13]
    v_pk_add_f32 v[218:219], v[218:219], v[14:15]
    v_cvt_pk_bf16_f32 v224, v212, v213
    v_cvt_pk_bf16_f32 v225, v214, v215
    v_mfma_f32_16x16x32_bf16 v[204:207], v[28:31], v[48:51], v[204:207]
    v_cvt_pk_bf16_f32 v226, v216, v217
    v_cvt_pk_bf16_f32 v227, v218, v219
    s_nop 0
    v_permlane16_swap_b32 v224, v226
    v_permlane16_swap_b32 v225, v227
    global_store_dwordx4 v188, v[224:227], s[42:43] sc1
    v_mfma_f32_16x16x32_bf16 v[208:211], v[20:23], v[48:51], v[208:211]
    v_mfma_f32_16x16x32_bf16 v[196:199], v[80:83], v[136:139], v[196:199]
    ds_read_b64 v[16:17], v6 offset:20288
    ds_read_b64 v[18:19], v6 offset:20296
    v_mfma_f32_16x16x32_bf16 v[196:199], v[84:87], v[132:135], v[196:199]
    ds_read_b128 v[72:75], v7 offset:7744
    s_add_u32 m0, s58, 30720
    s_waitcnt lgkmcnt(12)
    v_mfma_f32_16x16x32_bf16 v[196:199], v[88:91], v[128:131], v[196:199]
    ds_read_b64 v[20:21], v6 offset:19776
    buffer_load_dwordx4 v161, s[12:15], s25 offen offset:1024 lds
    v_mfma_f32_16x16x32_bf16 v[200:203], v[80:83], v[128:131], v[200:203]
    ds_read_b64 v[22:23], v6 offset:19784
    ds_read_b128 v[68:71], v7 offset:7232
    v_mfma_f32_16x16x32_bf16 v[196:199], v[92:95], v[124:127], v[196:199]
    ds_read_b64 v[24:25], v6 offset:19264
    v_mfma_f32_16x16x32_bf16 v[200:203], v[84:87], v[124:127], v[200:203]
    ds_read_b64 v[26:27], v6 offset:19272
    v_mfma_f32_16x16x32_bf16 v[204:207], v[80:83], v[124:127], v[204:207]
    ds_read_b128 v[64:67], v7 offset:6720
    ds_read_b64 v[28:29], v6 offset:18752
    s_waitcnt lgkmcnt(13)
    v_mfma_f32_16x16x32_bf16 v[196:199], v[96:99], v[120:123], v[196:199]
    ds_read_b64 v[30:31], v6 offset:18760
    v_mfma_f32_16x16x32_bf16 v[200:203], v[88:91], v[120:123], v[200:203]
    ds_read_b128 v[60:63], v7 offset:6208
    buffer_load_dwordx4 v162, s[12:15], s25 offen offset:2048 lds
    v_mfma_f32_16x16x32_bf16 v[204:207], v[84:87], v[120:123], v[204:207]
    ds_read_b64 v[32:33], v6 offset:18240
    ds_read_b64 v[34:35], v6 offset:18248
    v_mfma_f32_16x16x32_bf16 v[196:199], v[100:103], v[116:119], v[196:199]
    ds_read_b128 v[56:59], v7 offset:5696
    v_mfma_f32_16x16x32_bf16 v[200:203], v[92:95], v[116:119], v[200:203]
    ds_read_b64 v[36:37], v6 offset:17728
    v_mfma_f32_16x16x32_bf16 v[204:207], v[88:91], v[116:119], v[204:207]
    ds_read_b64 v[38:39], v6 offset:17736
    ds_read_b128 v[52:55], v7 offset:5184
    v_mfma_f32_16x16x32_bf16 v[208:211], v[80:83], v[116:119], v[208:211]
    ds_read_b64 v[40:41], v6 offset:17216
    s_waitcnt lgkmcnt(14)
    v_mfma_f32_16x16x32_bf16 v[196:199], v[104:107], v[112:115], v[196:199]
    ds_read_b64 v[42:43], v6 offset:17224
    v_mfma_f32_16x16x32_bf16 v[200:203], v[96:99], v[112:115], v[200:203]
    ds_read_b128 v[48:51], v7 offset:4672
    buffer_load_dword v237, v252, s[16:19], 0 offen
    v_mfma_f32_16x16x32_bf16 v[204:207], v[92:95], v[112:115], v[204:207]
    v_mfma_f32_16x16x32_bf16 v[208:211], v[84:87], v[112:115], v[208:211]
    v_mfma_f32_16x16x32_bf16 v[196:199], v[16:19], v[72:75], v[196:199]
    ds_read_b64 v[80:81], v6 offset:20224
    ds_read_b64 v[82:83], v6 offset:20232
    s_waitcnt lgkmcnt(11)
    v_mfma_f32_16x16x32_bf16 v[196:199], v[20:23], v[68:71], v[196:199]
    ds_read_b128 v[136:139], v7 offset:7680
PG6:
    s_cbranch_execz WARM1_0_ret
    s_add_u32 m0, s58, 36864
    v_mfma_f32_16x16x32_bf16 v[196:199], v[24:27], v[64:67], v[196:199]
    ds_read_b64 v[84:85], v6 offset:19712
    buffer_load_dwordx4 v160, s[12:15], s26 offen offset:0 lds
    v_mfma_f32_16x16x32_bf16 v[200:203], v[16:19], v[64:67], v[200:203]
    ds_read_b64 v[86:87], v6 offset:19720
    ds_read_b128 v[132:135], v7 offset:7168
    v_mfma_f32_16x16x32_bf16 v[196:199], v[28:31], v[60:63], v[196:199]
    ds_read_b64 v[88:89], v6 offset:19200
    v_mfma_f32_16x16x32_bf16 v[200:203], v[20:23], v[60:63], v[200:203]
    ds_read_b64 v[90:91], v6 offset:19208
    v_mfma_f32_16x16x32_bf16 v[204:207], v[16:19], v[60:63], v[204:207]
    ds_read_b128 v[128:131], v7 offset:6656
    ds_read_b64 v[92:93], v6 offset:18688
    buffer_load_dwordx4 v161, s[12:15], s26 offen offset:1024 lds
    s_waitcnt lgkmcnt(13)
    v_mfma_f32_16x16x32_bf16 v[196:199], v[32:35], v[56:59], v[196:199]
    ds_read_b64 v[94:95], v6 offset:18696
    v_mfma_f32_16x16x32_bf16 v[200:203], v[24:27], v[56:59], v[200:203]
    ds_read_b128 v[124:127], v7 offset:6144
    s_waitcnt vmcnt(5)
    s_mov_b32 exec_lo, s52
    s_mov_b32 exec_hi, 0
    global_store_dword v191, v192, s[42:43] sc1
    s_mov_b64 exec, -1
    v_mfma_f32_16x16x32_bf16 v[204:207], v[20:23], v[56:59], v[204:207]
    ds_read_b64 v[96:97], v6 offset:18176
    ds_read_b64 v[98:99], v6 offset:18184
    v_mfma_f32_16x16x32_bf16 v[196:199], v[36:39], v[52:55], v[196:199]
    ds_read_b128 v[120:123], v7 offset:5632
    buffer_load_dwordx4 v162, s[12:15], s26 offen offset:2048 lds
    v_mfma_f32_16x16x32_bf16 v[200:203], v[28:31], v[52:55], v[200:203]
    ds_read_b64 v[100:101], v6 offset:17664
    v_mfma_f32_16x16x32_bf16 v[204:207], v[24:27], v[52:55], v[204:207]
    ds_read_b64 v[102:103], v6 offset:17672
    ds_read_b128 v[116:119], v7 offset:5120
    v_mfma_f32_16x16x32_bf16 v[208:211], v[16:19], v[52:55], v[208:211]
    ds_read_b64 v[104:105], v6 offset:17152
    s_waitcnt lgkmcnt(14)
    v_mfma_f32_16x16x32_bf16 v[196:199], v[40:43], v[48:51], v[196:199]
    ds_read_b64 v[106:107], v6 offset:17160
    v_mfma_f32_16x16x32_bf16 v[200:203], v[32:35], v[48:51], v[200:203]
    ds_read_b128 v[112:115], v7 offset:4608
    v_mfma_f32_16x16x32_bf16 v[204:207], v[28:31], v[48:51], v[204:207]
    v_lshlrev_b32 v228, 16, v172
    v_and_b32 v229, 0xffff0000, v172
    v_mfma_f32_16x16x32_bf16 v[208:211], v[20:23], v[48:51], v[208:211]
    v_lshlrev_b32 v230, 16, v173
    v_and_b32 v231, 0xffff0000, v173
    v_mfma_f32_16x16x32_bf16 v[196:199], v[80:83], v[136:139], v[196:199]
    v_lshlrev_b32 v232, 16, v174
    v_and_b32 v233, 0xffff0000, v174
    s_waitcnt lgkmcnt(9)
    v_mfma_f32_16x16x32_bf16 v[196:199], v[84:87], v[132:135], v[196:199]
    s_add_u32 m0, s58, 43008
    v_lshlrev_b32 v234, 16, v175
    v_and_b32 v235, 0xffff0000, v175
    v_mfma_f32_16x16x32_bf16 v[196:199], v[88:91], v[128:131], v[196:199]
    buffer_load_dwordx4 v160, s[12:15], s27 offen offset:0 lds
    v_mul_f32 v228, s40, v228
    v_mul_f32 v229, s40, v229
    v_mfma_f32_16x16x32_bf16 v[200:203], v[80:83], v[128:131], v[200:203]
    v_mul_f32 v230, s40, v230
    v_mul_f32 v231, s40, v231
    v_mfma_f32_16x16x32_bf16 v[196:199], v[92:95], v[124:127], v[196:199]
    v_mul_f32 v232, s40, v232
    v_mul_f32 v233, s40, v233
    v_mfma_f32_16x16x32_bf16 v[200:203], v[84:87], v[124:127], v[200:203]
    v_mul_f32 v234, s40, v234
    v_mul_f32 v235, s40, v235
    v_mfma_f32_16x16x32_bf16 v[204:207], v[80:83], v[124:127], v[204:207]
    buffer_load_dwordx4 v161, s[12:15], s27 offen offset:1024 lds
    v_cvt_pk_bf16_f32 v172, v228, v229
    v_cvt_pk_bf16_f32 v173, v230, v231
    s_waitcnt lgkmcnt(3)
    v_mfma_f32_16x16x32_bf16 v[196:199], v[96:99], v[120:123], v[196:199]
    v_cvt_pk_bf16_f32 v174, v232, v233
    v_cvt_pk_bf16_f32 v175, v234, v235
    v_mfma_f32_16x16x32_bf16 v[200:203], v[88:91], v[120:123], v[200:203]
    v_lshlrev_b32 v244, 16, v172
    v_and_b32 v245, 0xffff0000, v172
    v_mfma_f32_16x16x32_bf16 v[204:207], v[84:87], v[120:123], v[204:207]
    v_lshlrev_b32 v246, 16, v173
    v_and_b32 v247, 0xffff0000, v173
    v_mfma_f32_16x16x32_bf16 v[196:199], v[100:103], v[116:119], v[196:199]
    buffer_load_dwordx4 v162, s[12:15], s27 offen offset:2048 lds
    v_lshlrev_b32 v248, 16, v174
    v_and_b32 v249, 0xffff0000, v174
    v_mfma_f32_16x16x32_bf16 v[200:203], v[92:95], v[116:119], v[200:203]
    v_lshlrev_b32 v250, 16, v175
    v_and_b32 v251, 0xffff0000, v175
    v_mfma_f32_16x16x32_bf16 v[204:207], v[88:91], v[116:119], v[204:207]
    v_and_b32 v8, 0xffff0000, v176
    v_and_b32 v9, 0xffff0000, v177
    v_mfma_f32_16x16x32_bf16 v[208:211], v[80:83], v[116:119], v[208:211]
    v_and_b32 v10, 0xffff0000, v178
    v_and_b32 v11, 0xffff0000, v179
    s_waitcnt lgkmcnt(0)
    v_mfma_f32_16x16x32_bf16 v[196:199], v[104:107], v[112:115], v[196:199]
    v_and_b32 v12, 0xffff0000, v180
    v_and_b32 v13, 0xffff0000, v181
    v_mfma_f32_16x16x32_bf16 v[200:203], v[96:99], v[112:115], v[200:203]
    v_and_b32 v14, 0xffff0000, v182
    v_and_b32 v15, 0xffff0000, v183
    v_mfma_f32_16x16x32_bf16 v[204:207], v[92:95], v[112:115], v[204:207]
    v_mfma_f32_16x16x32_bf16 v[208:211], v[84:87], v[112:115], v[208:211]
    s_cmp_eq_u32 s49, 0
    s_nop 4
    s_cbranch_scc1 XS_b1
    s_nop 4
    v_swap_b32 v196, v204
    v_swap_b32 v197, v205
    v_swap_b32 v198, v206
    v_swap_b32 v199, v207
    v_swap_b32 v200, v208
    v_swap_b32 v201, v209
    v_swap_b32 v202, v210
    v_swap_b32 v203, v211
XS_b1:
    ds_write_b128 v195, v[204:207] offset:0
    ds_write_b128 v195, v[208:211] offset:1024
    s_waitcnt lgkmcnt(0)
    s_barrier
A_conv_done:
PG7:
    s_cbranch_execz WARM1_0_ret
    ds_read_b128 v[212:215], v2 offset:0
    ds_read_b128 v[216:219], v2 offset:1024
    s_waitcnt lgkmcnt(0)
    v_pk_add_f32 v[212:213], v[212:213], v[196:197]
    v_pk_add_f32 v[214:215], v[214:215], v[198:199]
    v_pk_add_f32 v[216:217], v[216:217], v[200:201]
    v_pk_add_f32 v[218:219], v[218:219], v[202:203]
    s_mov_b32 s4, 0x3f80
    s_mov_b32 s5, 0x3f800000
    v_cvt_pk_bf16_f32 v220, v212, v213
    v_cvt_pk_bf16_f32 v221, v214, v215
    v_cvt_pk_bf16_f32 v222, v216, v217
    v_cvt_pk_bf16_f32 v223, v218, v219
    v_dot2_f32_bf16 v212, v220, s4, v244
    v_dot2_f32_bf16 v213, v220, s5, v245
    v_dot2_f32_bf16 v214, v221, s4, v246
    v_dot2_f32_bf16 v215, v221, s5, v247
    v_dot2_f32_bf16 v216, v222, s4, v248
    v_dot2_f32_bf16 v217, v222, s5, v249
    v_dot2_f32_bf16 v218, v223, s4, v250
    v_dot2_f32_bf16 v219, v223, s5, v251
    v_cvt_pk_bf16_f32 v220, v212, v213
    v_cvt_pk_bf16_f32 v221, v214, v215
    v_cvt_pk_bf16_f32 v222, v216, v217
    v_cvt_pk_bf16_f32 v223, v218, v219
    v_dot2_f32_bf16 v212, v220, s4, v8
    v_dot2_f32_bf16 v213, v220, s5, v9
    v_dot2_f32_bf16 v214, v221, s4, v10
    v_dot2_f32_bf16 v215, v221, s5, v11
    v_dot2_f32_bf16 v216, v222, s4, v12
    v_dot2_f32_bf16 v217, v222, s5, v13
    v_dot2_f32_bf16 v218, v223, s4, v14
    v_dot2_f32_bf16 v219, v223, s5, v15
    v_cvt_pk_bf16_f32 v224, v212, v213
    v_cvt_pk_bf16_f32 v225, v214, v215
    v_cvt_pk_bf16_f32 v226, v216, v217
    v_cvt_pk_bf16_f32 v227, v218, v219
    s_nop 0
    v_permlane16_swap_b32 v224, v226
    v_permlane16_swap_b32 v225, v227
    global_store_dwordx4 v189, v[224:227], s[42:43] sc1
    v_bfe_u32 v128, v1, 2, 2
    v_lshrrev_b32 v129, 5, v1
    v_lshl_add_u32 v129, v129, 3, v128
    v_lshlrev_b32 v131, 8, v129
    v_mul_u32_u24 v129, 192, v129
    s_lshl_b32 s4, s50, 1
    s_cmp_eq_u32 s54, 15
    s_cselect_b32 s4, s3, s4
    v_xor_b32 v128, s4, v128
    v_lshl_add_u32 v131, v128, 6, v131
    v_and_b32 v128, 1, v5
    v_lshl_add_u32 v129, v128, 4, v129
    v_lshl_add_u32 v131, v128, 5, v131
    v_and_b32 v128, 3, v1
    v_lshl_add_u32 v241, v128, 3, v131
    v_and_b32 v128, 1, v1
    v_lshl_add_u32 v129, v128, 3, v129
    v_bfe_u32 v130, v1, 1, 1
    v_mul_u32_u24 v128, 3072, v130
    s_mov_b32 s4, 59392
    v_add3_u32 v129, v129, v128, s4
    s_mul_i32 s4, s49, 3
    s_add_u32 s5, s4, 0
    v_xor_b32 v128, s5, v130
    v_lshl_add_u32 v238, v128, 5, v129
    s_add_u32 s5, s4, 1
    v_xor_b32 v128, s5, v130
    v_lshl_add_u32 v239, v128, 5, v129
    s_add_u32 s5, s4, 2
    v_xor_b32 v128, s5, v130
    v_lshl_add_u32 v240, v128, 5, v129
    v_mul_u32_u24 v128, 46080, v130
    v_add_u32 v242, 6144, v128
    s_lshl_b32 s4, s47, 15
    s_add_u32 s4, s4, 524288
    v_lshl_add_u32 v243, v0, 4, s4
    s_lshl_b32 s59, s53, 17
    s_add_u32 s59, s59, s57
    s_add_u32 s59, s59, 6291456
    s_add_u32 s32, s42, s59
    s_addc_u32 s33, s43, 0
    s_mov_b32 s34, 131072
    s_mov_b32 s35, 0x20000
    v_lshrrev_b32 v128, 3, v1
    v_and_b32 v129, 7, v1
    v_and_b32 v130, 1, v5
    v_lshlrev_b32 v130, 2, v130
    v_xor_b32 v129, v129, v130
    v_lshlrev_b32 v129, 4, v129
    v_lshl_add_u32 v129, v128, 10, v129
    s_and_b32 s56, s54, 7
    s_xor_b32 s56, s56, 1
    s_lshr_b32 s55, s54, 3
    s_lshl_b32 s4, s56, 7
    v_add_u32 v164, s4, v129
    v_bfe_u32 v128, v1, 2, 2
    v_lshrrev_b32 v129, 5, v1
    v_lshl_add_u32 v129, v129, 2, v128
    v_lshlrev_b32 v129, 7, v129
    v_lshrrev_b32 v128, 1, v128
    v_xor_b32 v128, s49, v128
    v_lshl_add_u32 v129, v128, 6, v129
    v_and_b32 v128, 1, v5
    v_lshl_add_u32 v129, v128, 5, v129
    v_and_b32 v128, 3, v1
    v_lshl_add_u32 v165, v128, 3, v129
    v_mov_b32 v16, v243
    ds_read_b64_tr_b16 a[244:245], v238 offset:0
    ds_read_b64_tr_b16 a[246:247], v238 offset:768
    ds_read_b64_tr_b16 a[248:249], v239 offset:0
    ds_read_b64_tr_b16 a[250:251], v239 offset:768
    ds_read_b64_tr_b16 a[252:253], v240 offset:0
    ds_read_b64_tr_b16 a[254:255], v240 offset:768
    s_and_b32 s4, s53, 1
    s_mul_i32 s4, s4, 3072
    v_add_u32 v12, v238, v242
    v_add_u32 v2, s4, v12
    ds_read_b64_tr_b16 v[28:29], v2 offset:0
    ds_read_b64_tr_b16 v[30:31], v2 offset:768
    v_add_u32 v13, v239, v242
    v_add_u32 v2, s4, v13
    ds_read_b64_tr_b16 v[32:33], v2 offset:0
    ds_read_b64_tr_b16 v[34:35], v2 offset:768
    v_add_u32 v14, v240, v242
    v_add_u32 v2, s4, v14
    ds_read_b64_tr_b16 v[36:37], v2 offset:0
    ds_read_b64_tr_b16 v[38:39], v2 offset:768
    ds_read_b64_tr_b16 a[124:125], v12 offset:0
    ds_read_b64_tr_b16 a[126:127], v12 offset:768
    ds_read_b64_tr_b16 a[128:129], v13 offset:0
    ds_read_b64_tr_b16 a[130:131], v13 offset:768
    ds_read_b64_tr_b16 a[132:133], v14 offset:0
    ds_read_b64_tr_b16 a[134:135], v14 offset:768
    ds_read_b64_tr_b16 a[136:137], v12 offset:3072
    ds_read_b64_tr_b16 a[138:139], v12 offset:3840
    ds_read_b64_tr_b16 a[140:141], v13 offset:3072
    ds_read_b64_tr_b16 a[142:143], v13 offset:3840
    ds_read_b64_tr_b16 a[144:145], v14 offset:3072
    ds_read_b64_tr_b16 a[146:147], v14 offset:3840
    global_load_dword v17, v16, s[42:43] sc1
    v_mov_b32 v60, 0x3f803f80
    v_mov_b32 v61, v60
    v_mov_b32 v62, v60
    v_mov_b32 v63, v60
    s_waitcnt lgkmcnt(12)
    s_nop 0
    v_mfma_f32_32x32x16_bf16 v[64:79], v[60:63], a[244:247], 0
    v_mov_b32 v10, v241
    v_xor_b32 v11, 64, v241
    v_mfma_f32_32x32x16_bf16 v[80:95], v[60:63], a[248:251], 0
    v_lshrrev_b32 v7, 5, v1
    v_cmp_ne_u32 vcc, s60, v193
    v_mfma_f32_32x32x16_bf16 v[96:111], v[60:63], a[252:255], 0
    s_lshl_b32 s4, s55, 1
    s_add_u32 s47, s4, s50
    s_cmp_eq_u64 vcc, 0
    s_cselect_b32 s40, 0, 268435456
    s_cselect_b32 s41, 268435456, 0
    v_mfma_f32_32x32x16_bf16 v[64:79], v[60:63], v[28:31], v[64:79]
    s_lshl_b32 s31, s3, 10
    s_lshl_b32 s28, s50, 13
    s_mul_i32 s29, s49, 49152
    s_add_u32 s29, s29, s28
    v_mfma_f32_32x32x16_bf16 v[80:95], v[60:63], v[32:35], v[80:95]
    s_add_u32 s45, s61, 7
    s_lshl_b32 s45, s45, 13
    s_lshl_b32 s4, s53, 7
    s_lshl_b32 s5, s3, 2
    s_add_u32 s4, s4, s5
    v_mfma_f32_32x32x16_bf16 v[96:111], v[60:63], v[36:39], v[96:111]
    s_add_u32 s1, s4, 208896
    v_mov_b32 v15, s1
    s_lshl_b32 s4, s54, 14
    s_lshl_b32 s5, s53, 10
    s_add_u32 s4, s4, s5
    s_lshl_b32 s5, s49, 9
    s_add_u32 s4, s4, s5
    s_add_u32 s4, s4, 262144
    s_cmp_eq_u32 s50, 0
    s_cselect_b32 s4, s4, 268435456
    s_waitcnt vmcnt(1)
    s_lshl_b32 exec_lo, s52, 8
    s_mov_b32 exec_hi, 0
    global_store_dword v191, v192, s[42:43] sc1
    s_mov_b64 exec, -1
    v_mov_b32 v60, v64
    v_mov_b32 v61, v80
    v_mov_b32 v62, v96
    v_mov_b32 v63, s44
    s_mov_b32 exec_hi, 0
    buffer_store_dwordx4 v[60:63], v163, s[8:11], s4 offen sc1
    s_mov_b32 exec_hi, -1
    s_mov_b32 s6, 0
    s_waitcnt vmcnt(2)
H2_poll:
    v_subrev_u32 v17, s44, v17
    v_cmpx_lt_u32 vcc, 15, v17
    s_cbranch_execz H2_poll_done
    s_add_u32 s6, s6, 1
    s_cmp_gt_u32 s6, 1048576
    s_cbranch_scc1 H2_poll_done
    global_load_dword v17, v16, s[42:43] sc1
    s_waitcnt vmcnt(0)
    s_branch H2_poll
H2_poll_done:
    s_mov_b64 exec, -1
    s_cmp_eq_u32 s54, 15
    s_cbranch_scc1 G1_stats
    s_add_u32 m0, s57, 0
    s_add_u32 s45, s45, 8192
    s_and_b32 s45, s45, 0xffff
    buffer_load_dwordx4 v163, s[32:35], s45 offen sc1 lds
    buffer_load_dwordx4 v163, s[32:35], s45 offen offset:1024 sc1 lds
    s_add_u32 m0, s57, 8192
    s_add_u32 s45, s45, 8192
    s_and_b32 s45, s45, 0xffff
    buffer_load_dwordx4 v163, s[32:35], s45 offen sc1 lds
    buffer_load_dwordx4 v163, s[32:35], s45 offen offset:1024 sc1 lds
    s_add_u32 m0, s57, 16384
    s_add_u32 s45, s45, 8192
    s_and_b32 s45, s45, 0xffff
    buffer_load_dwordx4 v163, s[32:35], s45 offen sc1 lds
    buffer_load_dwordx4 v163, s[32:35], s45 offen offset:1024 sc1 lds
    s_add_u32 m0, s57, 24576
    s_add_u32 s45, s45, 8192
    s_and_b32 s45, s45, 0xffff
    buffer_load_dwordx4 v163, s[32:35], s45 offen sc1 lds
    buffer_load_dwordx4 v163, s[32:35], s45 offen offset:1024 sc1 lds
    ds_read_b64_tr_b16 a[148:149], v12 offset:6144
    ds_read_b64_tr_b16 a[150:151], v12 offset:6912
    ds_read_b64_tr_b16 a[152:153], v13 offset:6144
    ds_read_b64_tr_b16 a[154:155], v13 offset:6912
    ds_read_b64_tr_b16 a[156:157], v14 offset:6144
    ds_read_b64_tr_b16 a[158:159], v14 offset:6912
    ds_read_b64_tr_b16 a[160:161], v12 offset:9216
    ds_read_b64_tr_b16 a[162:163], v12 offset:9984
    ds_read_b64_tr_b16 a[164:165], v13 offset:9216
    ds_read_b64_tr_b16 a[166:167], v13 offset:9984
    ds_read_b64_tr_b16 a[168:169], v14 offset:9216
    ds_read_b64_tr_b16 a[170:171], v14 offset:9984
    ds_read_b64_tr_b16 a[172:173], v12 offset:12288
    ds_read_b64_tr_b16 a[174:175], v12 offset:13056
    ds_read_b64_tr_b16 a[176:177], v13 offset:12288
    ds_read_b64_tr_b16 a[178:179], v13 offset:13056
    ds_read_b64_tr_b16 a[180:181], v14 offset:12288
    ds_read_b64_tr_b16 a[182:183], v14 offset:13056
    ds_read_b64_tr_b16 a[184:185], v12 offset:15360
    ds_read_b64_tr_b16 a[186:187], v12 offset:16128
    ds_read_b64_tr_b16 a[188:189], v13 offset:15360
    ds_read_b64_tr_b16 a[190:191], v13 offset:16128
    ds_read_b64_tr_b16 a[192:193], v14 offset:15360
    ds_read_b64_tr_b16 a[194:195], v14 offset:16128
    ds_read_b64_tr_b16 a[196:197], v12 offset:18432
    ds_read_b64_tr_b16 a[198:199], v12 offset:19200
    ds_read_b64_tr_b16 a[200:201], v13 offset:18432
    ds_read_b64_tr_b16 a[202:203], v13 offset:19200
    ds_read_b64_tr_b16 a[204:205], v14 offset:18432
    ds_read_b64_tr_b16 a[206:207], v14 offset:19200
    ds_read_b64_tr_b16 a[208:209], v12 offset:21504
    ds_read_b64_tr_b16 a[210:211], v12 offset:22272
    ds_read_b64_tr_b16 a[212:213], v13 offset:21504
    ds_read_b64_tr_b16 a[214:215], v13 offset:22272
    ds_read_b64_tr_b16 a[216:217], v14 offset:21504
    ds_read_b64_tr_b16 a[218:219], v14 offset:22272
    s_waitcnt lgkmcnt(0)
    s_barrier
    v_add_u32 v160, 2752, v160
    v_add_u32 v161, 2752, v161
    v_add_u32 v162, 2752, v162
    s_add_u32 m0, s31, 32768
    s_add_u32 s30, s29, 0
    buffer_load_dwordx4 v164, s[16:19], s30 offen  lds
    s_add_u32 m0, s31, 36864
    s_add_u32 s30, s29, 98304
    buffer_load_dwordx4 v164, s[16:19], s30 offen  lds
    s_add_u32 m0, s31, 40960
    s_add_u32 s30, s29, 196608
    buffer_load_dwordx4 v164, s[16:19], s30 offen  lds
    s_add_u32 m0, s58, 0
    s_nop 0
    buffer_load_dwordx4 v160, s[12:15], s20 offen offset:0  lds
    s_add_u32 m0, s58, 0
    s_nop 0
    buffer_load_dwordx4 v161, s[12:15], s20 offen offset:1024  lds
    s_add_u32 m0, s58, 0
    s_nop 0
    buffer_load_dwordx4 v162, s[12:15], s20 offen offset:2048  lds
    s_add_u32 m0, s58, 6144
    s_nop 0
    buffer_load_dwordx4 v160, s[12:15], s21 offen offset:0  lds
    s_add_u32 m0, s58, 6144
    s_nop 0
    buffer_load_dwordx4 v161, s[12:15], s21 offen offset:1024  lds
    s_add_u32 m0, s58, 6144
    s_nop 0
    buffer_load_dwordx4 v162, s[12:15], s21 offen offset:2048  lds
    s_mov_b64 exec, 0
    s_cmp_eq_u32 s3, 0
    s_cbranch_scc1 PG8
    s_cmp_eq_u32 s3, 1
    s_cbranch_scc1 PG9
    s_cmp_eq_u32 s3, 2
    s_cbranch_scc1 PG10
    s_cmp_eq_u32 s3, 3
    s_cbranch_scc1 PG11
WARM2_0_ret:
    s_mov_b64 exec, -1
    s_or_b32 s4, s2, s3
    s_cmp_eq_u32 s4, 0
    s_cbranch_scc0 H2_nonn
    v_mov_b32 v2, 0
    v_mov_b32 v3, s44
    s_mov_b64 exec, 1
    global_store_dword v2, v3, s[42:43] sc1
    s_mov_b64 exec, -1
H2_nonn:
    ds_read_b64_tr_b16 a[220:221], v12 offset:24576
    ds_read_b64_tr_b16 a[222:223], v12 offset:25344
    ds_read_b64_tr_b16 a[224:225], v13 offset:24576
    ds_read_b64_tr_b16 a[226:227], v13 offset:25344
    ds_read_b64_tr_b16 a[228:229], v14 offset:24576
    ds_read_b64_tr_b16 a[230:231], v14 offset:25344
    s_waitcnt vmcnt(15)
    s_barrier
    ds_read_b64_tr_b16 v[20:21], v10 offset:0
    ds_read_b64_tr_b16 v[22:23], v10 offset:1024
    ds_read_b64_tr_b16 v[24:25], v11 offset:0
    ds_read_b64_tr_b16 v[26:27], v11 offset:1024
    s_waitcnt lgkmcnt(0)
    v_mfma_f32_32x32x16_bf16 v[64:79], a[124:127], v[20:23], 0
    ds_read_b64_tr_b16 v[40:41], v10 offset:4096
    ds_read_b64_tr_b16 v[42:43], v10 offset:5120
    global_load_dword v18, v15, s[42:43] sc1
    v_mfma_f32_32x32x16_bf16 v[80:95], a[124:127], v[24:27], 0
    ds_read_b64_tr_b16 v[44:45], v11 offset:4096
    ds_read_b64_tr_b16 v[46:47], v11 offset:5120
    s_add_u32 m0, s58, 12288
    s_nop 0
    buffer_load_dwordx4 v160, s[12:15], s22 offen offset:0  lds
    v_mfma_f32_32x32x16_bf16 v[96:111], a[128:131], v[20:23], 0
    ds_read_b64_tr_b16 a[232:233], v12 offset:27648
    ds_read_b64_tr_b16 a[234:235], v12 offset:28416
    v_mfma_f32_32x32x16_bf16 v[112:127], a[128:131], v[24:27], 0
    ds_read_b64_tr_b16 a[236:237], v13 offset:27648
    ds_read_b64_tr_b16 a[238:239], v13 offset:28416
    buffer_load_dwordx4 v161, s[12:15], s22 offen offset:1024  lds
    v_mfma_f32_32x32x16_bf16 v[128:143], a[132:135], v[20:23], 0
    ds_read_b64_tr_b16 a[240:241], v14 offset:27648
    ds_read_b64_tr_b16 a[242:243], v14 offset:28416
    v_mfma_f32_32x32x16_bf16 v[144:159], a[132:135], v[24:27], 0
    buffer_load_dwordx4 v162, s[12:15], s22 offen offset:2048  lds
    s_waitcnt lgkmcnt(6)
    v_mfma_f32_32x32x16_bf16 v[64:79], a[136:139], v[40:43], v[64:79]
    s_add_u32 m0, s57, 0
    s_add_u32 s45, s45, 8192
    s_and_b32 s45, s45, 0xffff
    v_mfma_f32_32x32x16_bf16 v[80:95], a[136:139], v[44:47], v[80:95]
    s_waitcnt vmcnt(10) lgkmcnt(0)
    s_barrier
    ds_read_b64_tr_b16 v[20:21], v10 offset:8192
    ds_read_b64_tr_b16 v[22:23], v10 offset:9216
    v_mfma_f32_32x32x16_bf16 v[96:111], a[140:143], v[40:43], v[96:111]
    ds_read_b64_tr_b16 v[24:25], v11 offset:8192
    ds_read_b64_tr_b16 v[26:27], v11 offset:9216
    ds_read_b64_tr_b16 a[124:125], v12 offset:30720
    buffer_load_dwordx4 v163, s[32:35], s45 offen sc1 lds
    v_mfma_f32_32x32x16_bf16 v[112:127], a[140:143], v[44:47], v[112:127]
    ds_read_b64_tr_b16 a[126:127], v12 offset:31488
    ds_read_b64_tr_b16 a[128:129], v13 offset:30720
    ds_read_b64_tr_b16 a[130:131], v13 offset:31488
    v_mfma_f32_32x32x16_bf16 v[128:143], a[144:147], v[40:43], v[128:143]
    ds_read_b64_tr_b16 a[132:133], v14 offset:30720
    ds_read_b64_tr_b16 a[134:135], v14 offset:31488
    buffer_load_dwordx4 v163, s[32:35], s45 offen offset:1024 sc1 lds
    v_mfma_f32_32x32x16_bf16 v[144:159], a[144:147], v[44:47], v[144:159]
    s_add_u32 m0, s58, 18432
    s_waitcnt lgkmcnt(6)
    v_mfma_f32_32x32x16_bf16 v[64:79], a[148:151], v[20:23], v[64:79]
    ds_read_b64_tr_b16 v[40:41], v10 offset:12288
    ds_read_b64_tr_b16 v[42:43], v10 offset:13312
    buffer_load_dwordx4 v160, s[12:15], s23 offen offset:0  lds
    ds_read_b64_tr_b16 a[0:1], v165 offset:32768
    ds_read_b64_tr_b16 a[2:3], v165 offset:33792
    v_mfma_f32_32x32x16_bf16 v[80:95], a[148:151], v[24:27], v[80:95]
    ds_read_b64_tr_b16 v[44:45], v11 offset:12288
    ds_read_b64_tr_b16 v[46:47], v11 offset:13312
    ds_read_b64_tr_b16 a[4:5], v165 offset:34816
    ds_read_b64_tr_b16 a[6:7], v165 offset:35840
    ds_read_b64_tr_b16 a[8:9], v165 offset:36864
    v_mfma_f32_32x32x16_bf16 v[96:111], a[152:155], v[20:23], v[96:111]
    ds_read_b64_tr_b16 a[136:137], v12 offset:33792
    ds_read_b64_tr_b16 a[138:139], v12 offset:34560
    buffer_load_dwordx4 v161, s[12:15], s23 offen offset:1024  lds
    ds_read_b64_tr_b16 a[10:11], v165 offset:37888
    ds_read_b64_tr_b16 a[12:13], v165 offset:38912
    v_mfma_f32_32x32x16_bf16 v[112:127], a[152:155], v[24:27], v[112:127]
    ds_read_b64_tr_b16 a[140:141], v13 offset:33792
    ds_read_b64_tr_b16 a[142:143], v13 offset:34560
    ds_read_b64_tr_b16 a[14:15], v165 offset:39936
    ds_read_b64_tr_b16 a[16:17], v165 offset:40960
    ds_read_b64_tr_b16 a[18:19], v165 offset:41984
    v_mfma_f32_32x32x16_bf16 v[128:143], a[156:159], v[20:23], v[128:143]
    ds_read_b64_tr_b16 a[144:145], v14 offset:33792
    ds_read_b64_tr_b16 a[146:147], v14 offset:34560
    buffer_load_dwordx4 v162, s[12:15], s23 offen offset:2048  lds
    ds_read_b64_tr_b16 a[20:21], v165 offset:43008
    ds_read_b64_tr_b16 a[22:23], v165 offset:44032
    v_mfma_f32_32x32x16_bf16 v[144:159], a[156:159], v[24:27], v[144:159]
    s_add_u32 m0, s57, 8192
    s_add_u32 s45, s45, 8192
    s_and_b32 s45, s45, 0xffff
    s_lshl_b32 s4, s53, 8
    s_waitcnt lgkmcnt(14)
    v_mfma_f32_32x32x16_bf16 v[64:79], a[160:163], v[40:43], v[64:79]
    s_add_u32 s4, s4, 196608
    s_lshl_b32 s7, s55, 7
    s_add_u32 s7, s7, s4
    v_min_u32 v16, 28, v1
    v_lshl_add_u32 v16, v16, 2, s7
    v_mfma_f32_32x32x16_bf16 v[80:95], a[160:163], v[44:47], v[80:95]
    s_waitcnt vmcnt(20) lgkmcnt(0)
    s_barrier
    ds_read_b64_tr_b16 v[20:21], v10 offset:16384
    ds_read_b64_tr_b16 v[22:23], v10 offset:17408
    v_mfma_f32_32x32x16_bf16 v[96:111], a[164:167], v[40:43], v[96:111]
    ds_read_b64_tr_b16 v[24:25], v11 offset:16384
    ds_read_b64_tr_b16 v[26:27], v11 offset:17408
    ds_read_b64_tr_b16 a[148:149], v12 offset:36864
    buffer_load_dwordx4 v163, s[32:35], s45 offen sc1 lds
    v_mfma_f32_32x32x16_bf16 v[112:127], a[164:167], v[44:47], v[112:127]
    ds_read_b64_tr_b16 a[150:151], v12 offset:37632
    ds_read_b64_tr_b16 a[152:153], v13 offset:36864
    ds_read_b64_tr_b16 a[154:155], v13 offset:37632
    s_lshl_b32 s5, s54, 1
    v_mfma_f32_32x32x16_bf16 v[128:143], a[168:171], v[40:43], v[128:143]
    ds_read_b64_tr_b16 a[156:157], v14 offset:36864
    ds_read_b64_tr_b16 a[158:159], v14 offset:37632
    buffer_load_dwordx4 v163, s[32:35], s45 offen offset:1024 sc1 lds
    s_add_u32 s61, s5, s49
    v_mfma_f32_32x32x16_bf16 v[144:159], a[168:171], v[44:47], v[144:159]
    s_add_u32 m0, s58, 24576
    s_lshl_b32 s5, s50, 5
    s_add_u32 s5, s5, s61
    s_lshl_b32 s5, s5, 2
    s_waitcnt lgkmcnt(6)
    v_mfma_f32_32x32x16_bf16 v[64:79], a[172:175], v[20:23], v[64:79]
    ds_read_b64_tr_b16 v[40:41], v10 offset:20480
    ds_read_b64_tr_b16 v[42:43], v10 offset:21504
    buffer_load_dwordx4 v160, s[12:15], s24 offen offset:0  lds
    s_add_u32 s5, s5, s4
    v_mfma_f32_32x32x16_bf16 v[80:95], a[172:175], v[24:27], v[80:95]
    ds_read_b64_tr_b16 v[44:45], v11 offset:20480
    ds_read_b64_tr_b16 v[46:47], v11 offset:21504
    v_mov_b32 v19, s5
    s_lshl_b32 s4, s53, 2
    v_mfma_f32_32x32x16_bf16 v[96:111], a[176:179], v[20:23], v[96:111]
    ds_read_b64_tr_b16 a[160:161], v12 offset:39936
    ds_read_b64_tr_b16 a[162:163], v12 offset:40704
    buffer_load_dwordx4 v161, s[12:15], s24 offen offset:1024  lds
    s_lshl_b32 s5, s50, 1
    v_mfma_f32_32x32x16_bf16 v[112:127], a[176:179], v[24:27], v[112:127]
    ds_read_b64_tr_b16 a[164:165], v13 offset:39936
    ds_read_b64_tr_b16 a[166:167], v13 offset:40704
    s_add_u32 s5, s4, s5
    s_mul_i32 s5, s5, 88064
    v_mfma_f32_32x32x16_bf16 v[128:143], a[180:183], v[20:23], v[128:143]
    ds_read_b64_tr_b16 a[168:169], v14 offset:39936
    ds_read_b64_tr_b16 a[170:171], v14 offset:40704
    buffer_load_dwordx4 v162, s[12:15], s24 offen offset:2048  lds
    s_lshl_b32 s52, s61, 10
    v_mfma_f32_32x32x16_bf16 v[144:159], a[180:183], v[24:27], v[144:159]
    s_add_u32 m0, s57, 16384
    s_add_u32 s45, s45, 8192
    s_and_b32 s45, s45, 0xffff
    s_add_u32 s52, s52, s5
    s_waitcnt lgkmcnt(6)
    v_mfma_f32_32x32x16_bf16 v[64:79], a[184:187], v[40:43], v[64:79]
    s_add_u32 s52, s52, 8388608
    s_add_u32 s4, s4, s47
    s_mul_i32 s4, s4, 88064
    s_add_u32 s4, s4, 8388608
    s_lshl_b32 s37, s50, 13
    v_mfma_f32_32x32x16_bf16 v[80:95], a[184:187], v[44:47], v[80:95]
    s_waitcnt vmcnt(23) lgkmcnt(0)
    s_barrier
    ds_read_b64_tr_b16 v[20:21], v10 offset:24576
    ds_read_b64_tr_b16 v[22:23], v10 offset:25600
    v_mfma_f32_32x32x16_bf16 v[96:111], a[188:191], v[40:43], v[96:111]
    ds_read_b64_tr_b16 v[24:25], v11 offset:24576
    ds_read_b64_tr_b16 v[26:27], v11 offset:25600
    ds_read_b64_tr_b16 a[172:173], v12 offset:43008
    buffer_load_dwordx4 v163, s[32:35], s45 offen sc1 lds
    v_mfma_f32_32x32x16_bf16 v[112:127], a[188:191], v[44:47], v[112:127]
    ds_read_b64_tr_b16 a[174:175], v12 offset:43776
PG8:
    s_cbranch_execz WARM2_0_ret
    ds_read_b64_tr_b16 a[176:177], v13 offset:43008
    ds_read_b64_tr_b16 a[178:179], v13 offset:43776
    s_mul_i32 s5, s49, 3072
    v_mfma_f32_32x32x16_bf16 v[128:143], a[192:195], v[40:43], v[128:143]
    ds_read_b64_tr_b16 a[180:181], v14 offset:43008
    ds_read_b64_tr_b16 a[182:183], v14 offset:43776
    buffer_load_dwordx4 v163, s[32:35], s45 offen offset:1024 sc1 lds
    s_add_u32 s48, s4, s5
    v_mfma_f32_32x32x16_bf16 v[144:159], a[192:195], v[44:47], v[144:159]
    s_add_u32 m0, s58, 30720
    s_add_u32 s48, s48, 81920
    s_add_u32 s51, s37, s5
    s_add_u32 s51, s51, 32768
    s_waitcnt lgkmcnt(6)
    v_mfma_f32_32x32x16_bf16 v[64:79], a[196:199], v[20:23], v[64:79]
    ds_read_b64_tr_b16 v[40:41], v10 offset:28672
    ds_read_b64_tr_b16 v[42:43], v10 offset:29696
    s_lshl_b32 s5, s49, 12
    s_add_u32 s36, s4, s5
    s_add_u32 s37, s37, s5
    v_mfma_f32_32x32x16_bf16 v[80:95], a[196:199], v[24:27], v[80:95]
    ds_read_b64_tr_b16 v[44:45], v11 offset:28672
    ds_read_b64_tr_b16 v[46:47], v11 offset:29696
    buffer_load_dwordx4 v160, s[12:15], s25 offen offset:0  lds
    v_mfma_f32_32x32x16_bf16 v[96:111], a[200:203], v[20:23], v[96:111]
    ds_read_b64_tr_b16 a[184:185], v12 offset:46080
    ds_read_b64_tr_b16 a[186:187], v12 offset:46848
    s_mul_i32 s60, s50, 49152
    s_add_u32 s60, s60, s5
    s_add_u32 s60, s60, 65536
    v_mfma_f32_32x32x16_bf16 v[112:127], a[200:203], v[24:27], v[112:127]
    ds_read_b64_tr_b16 a[188:189], v13 offset:46080
    ds_read_b64_tr_b16 a[190:191], v13 offset:46848
    v_add_u32 v4, 65536, v165
    v_add_u32 v5, 114688, v165
    v_mfma_f32_32x32x16_bf16 v[128:143], a[204:207], v[20:23], v[128:143]
    ds_read_b64_tr_b16 a[192:193], v14 offset:46080
    ds_read_b64_tr_b16 a[194:195], v14 offset:46848
    buffer_load_dwordx4 v161, s[12:15], s25 offen offset:1024  lds
    v_and_b32 v8, 31, v1
    v_mfma_f32_32x32x16_bf16 v[144:159], a[204:207], v[24:27], v[144:159]
    s_add_u32 m0, s57, 24576
    s_add_u32 s45, s45, 8192
    s_and_b32 s45, s45, 0xffff
    v_lshlrev_b32 v8, 4, v8
    s_waitcnt lgkmcnt(6)
    v_mfma_f32_32x32x16_bf16 v[64:79], a[208:211], v[40:43], v[64:79]
    s_lshl_b32 s0, s54, 11
    s_lshl_b32 s5, s49, 10
    s_add_u32 s0, s0, s5
    s_add_u32 s0, s0, 229376
    s_lshl_b32 s46, s53, 11
    v_mfma_f32_32x32x16_bf16 v[80:95], a[208:211], v[44:47], v[80:95]
    s_waitcnt vmcnt(12) lgkmcnt(0)
    s_barrier
    ds_read_b64_tr_b16 v[20:21], v10 offset:0
    ds_read_b64_tr_b16 v[22:23], v10 offset:1024
    v_mfma_f32_32x32x16_bf16 v[96:111], a[212:215], v[40:43], v[96:111]
    ds_read_b64_tr_b16 v[24:25], v11 offset:0
    ds_read_b64_tr_b16 v[26:27], v11 offset:1024
    ds_read_b64_tr_b16 a[196:197], v12 offset:0
    buffer_load_dwordx4 v163, s[32:35], s45 offen sc1 lds
    v_mfma_f32_32x32x16_bf16 v[112:127], a[212:215], v[44:47], v[112:127]
    ds_read_b64_tr_b16 a[198:199], v12 offset:768
    ds_read_b64_tr_b16 a[200:201], v13 offset:0
    ds_read_b64_tr_b16 a[202:203], v13 offset:768
    s_lshl_b32 s5, s50, 10
    v_mfma_f32_32x32x16_bf16 v[128:143], a[216:219], v[40:43], v[128:143]
    ds_read_b64_tr_b16 a[204:205], v14 offset:0
    ds_read_b64_tr_b16 a[206:207], v14 offset:768
    buffer_load_dwordx4 v163, s[32:35], s45 offen offset:1024 sc1 lds
    s_add_u32 s46, s46, s5
    v_mfma_f32_32x32x16_bf16 v[144:159], a[216:219], v[44:47], v[144:159]
    s_add_u32 m0, s58, 30720
    s_add_u32 s46, s46, 65536
    v_mov_b32 v229, 0
    v_mov_b32 v230, 0
    s_waitcnt lgkmcnt(6)
    v_mfma_f32_32x32x16_bf16 v[64:79], a[220:223], v[20:23], v[64:79]
    ds_read_b64_tr_b16 v[40:41], v10 offset:4096
    ds_read_b64_tr_b16 v[42:43], v10 offset:5120
    v_mov_b32 v231, 0
    v_mov_b32 v233, 0
    v_mov_b32 v234, 0
    v_mfma_f32_32x32x16_bf16 v[80:95], a[220:223], v[24:27], v[80:95]
    ds_read_b64_tr_b16 v[44:45], v11 offset:4096
    ds_read_b64_tr_b16 v[46:47], v11 offset:5120
    buffer_load_dwordx4 v162, s[12:15], s25 offen offset:2048  lds
    v_mfma_f32_32x32x16_bf16 v[96:111], a[224:227], v[20:23], v[96:111]
    ds_read_b64_tr_b16 a[208:209], v12 offset:3072
    ds_read_b64_tr_b16 a[210:211], v12 offset:3840
    s_add_u32 m0, s58, 36864
    v_mov_b32 v235, 0
    v_mov_b32 v209, 0
    v_mfma_f32_32x32x16_bf16 v[112:127], a[224:227], v[24:27], v[112:127]
    s_load_dword s1, s[42:43], s1
    ds_read_b64_tr_b16 a[212:213], v13 offset:3072
    ds_read_b64_tr_b16 a[214:215], v13 offset:3840
    v_mov_b32 v210, 0
    v_mov_b32 v211, 0
    v_mfma_f32_32x32x16_bf16 v[128:143], a[228:231], v[20:23], v[128:143]
    ds_read_b64_tr_b16 a[216:217], v14 offset:3072
    ds_read_b64_tr_b16 a[218:219], v14 offset:3840
    buffer_load_dwordx4 v160, s[12:15], s26 offen offset:0  lds
    v_mov_b32 v213, 0
    v_mfma_f32_32x32x16_bf16 v[144:159], a[228:231], v[24:27], v[144:159]
    v_mov_b32 v214, 0
    v_mov_b32 v215, 0
    v_mov_b32 v217, 0
    v_mov_b32 v218, 0
    s_waitcnt lgkmcnt(6)
    v_mfma_f32_32x32x16_bf16 v[64:79], a[232:235], v[40:43], v[64:79]
    v_mov_b32 v219, 0
    v_mov_b32 v220, 0x01000100
    v_mfma_f32_32x32x16_bf16 v[80:95], a[232:235], v[44:47], v[80:95]
    s_waitcnt vmcnt(11) lgkmcnt(0)
    s_barrier
    s_cmp_lg_u32 s44, s1
    s_cbranch_scc1 H2_slow
H2_ok:
    ds_read_b64_tr_b16 v[20:21], v10 offset:8192
    ds_read_b64_tr_b16 v[22:23], v10 offset:9216
    v_mfma_f32_32x32x16_bf16 v[96:111], a[236:239], v[40:43], v[96:111]
    ds_read_b64_tr_b16 v[24:25], v11 offset:8192
    ds_read_b64_tr_b16 v[26:27], v11 offset:9216
    ds_read_b64_tr_b16 a[220:221], v12 offset:6144
    global_load_dword v17, v16, s[42:43] sc1
    v_mfma_f32_32x32x16_bf16 v[112:127], a[236:239], v[44:47], v[112:127]
    ds_read_b64_tr_b16 a[222:223], v12 offset:6912
    ds_read_b64_tr_b16 a[224:225], v13 offset:6144
    ds_read_b64_tr_b16 a[226:227], v13 offset:6912
    s_add_u32 m0, s57, 0
    s_add_u32 s45, s45, 8192
    s_and_b32 s45, s45, 0xffff
    s_add_u32 s32, s32, 0x10000
    s_addc_u32 s33, s33, 0
    buffer_load_dwordx4 v163, s[32:35], s45 offen sc1 lds
    v_mfma_f32_32x32x16_bf16 v[128:143], a[240:243], v[40:43], v[128:143]
    ds_read_b64_tr_b16 a[228:229], v14 offset:6144
    ds_read_b64_tr_b16 a[230:231], v14 offset:6912
    v_mfma_f32_32x32x16_bf16 v[144:159], a[240:243], v[44:47], v[144:159]
    buffer_load_dwordx4 v163, s[32:35], s45 offen offset:1024 sc1 lds
    s_waitcnt lgkmcnt(6)
    v_mfma_f32_32x32x16_bf16 v[64:79], a[124:127], v[20:23], v[64:79]
    ds_read_b64_tr_b16 v[40:41], v10 offset:12288
    ds_read_b64_tr_b16 v[42:43], v10 offset:13312
    s_add_u32 m0, s58, 36864
    s_nop 0
    buffer_load_dwordx4 v161, s[12:15], s26 offen offset:1024  lds
    v_mfma_f32_32x32x16_bf16 v[80:95], a[124:127], v[24:27], v[80:95]
    ds_read_b64_tr_b16 v[44:45], v11 offset:12288
    ds_read_b64_tr_b16 v[46:47], v11 offset:13312
    v_mfma_f32_32x32x16_bf16 v[96:111], a[128:131], v[20:23], v[96:111]
    ds_read_b64_tr_b16 a[232:233], v12 offset:9216
    ds_read_b64_tr_b16 a[234:235], v12 offset:9984
    buffer_load_dwordx4 v162, s[12:15], s26 offen offset:2048  lds
    v_mfma_f32_32x32x16_bf16 v[112:127], a[128:131], v[24:27], v[112:127]
    ds_read_b64_tr_b16 a[236:237], v13 offset:9216
    ds_read_b64_tr_b16 a[238:239], v13 offset:9984
    s_add_u32 m0, s31, 45056
    s_add_u32 s30, s29, 589824
    buffer_load_dwordx4 v164, s[16:19], s30 offen  lds
    v_mfma_f32_32x32x16_bf16 v[128:143], a[132:135], v[20:23], v[128:143]
    ds_read_b64_tr_b16 a[240:241], v14 offset:9216
    ds_read_b64_tr_b16 a[242:243], v14 offset:9984
    s_add_u32 m0, s31, 49152
    s_add_u32 s30, s29, 688128
    v_mfma_f32_32x32x16_bf16 v[144:159], a[132:135], v[24:27], v[144:159]
    buffer_load_dwordx4 v164, s[16:19], s30 offen  lds
    s_waitcnt lgkmcnt(6)
    v_mfma_f32_32x32x16_bf16 v[64:79], a[136:139], v[40:43], v[64:79]
    s_add_u32 m0, s57, 8192
    s_add_u32 s45, s45, 8192
    s_and_b32 s45, s45, 0xffff
    v_mfma_f32_32x32x16_bf16 v[80:95], a[136:139], v[44:47], v[80:95]
    s_waitcnt vmcnt(13) lgkmcnt(0)
    s_barrier
    ds_read_b64_tr_b16 v[20:21], v10 offset:16384
    ds_read_b64_tr_b16 v[22:23], v10 offset:17408
    v_mfma_f32_32x32x16_bf16 v[96:111], a[140:143], v[40:43], v[96:111]
    ds_read_b64_tr_b16 v[24:25], v11 offset:16384
    ds_read_b64_tr_b16 v[26:27], v11 offset:17408
    ds_read_b64_tr_b16 a[124:125], v12 offset:12288
    buffer_load_dwordx4 v163, s[32:35], s45 offen sc1 lds
    v_mfma_f32_32x32x16_bf16 v[112:127], a[140:143], v[44:47], v[112:127]
    ds_read_b64_tr_b16 a[126:127], v12 offset:13056
    ds_read_b64_tr_b16 a[128:129], v13 offset:12288
    ds_read_b64_tr_b16 a[130:131], v13 offset:13056
    v_mfma_f32_32x32x16_bf16 v[128:143], a[144:147], v[40:43], v[128:143]
    ds_read_b64_tr_b16 a[132:133], v14 offset:12288
    ds_read_b64_tr_b16 a[134:135], v14 offset:13056
    buffer_load_dwordx4 v163, s[32:35], s45 offen offset:1024 sc1 lds
    v_mfma_f32_32x32x16_bf16 v[144:159], a[144:147], v[44:47], v[144:159]
    s_add_u32 m0, s58, 43008
    s_waitcnt lgkmcnt(6)
    v_mfma_f32_32x32x16_bf16 v[64:79], a[148:151], v[20:23], v[64:79]
    ds_read_b64_tr_b16 v[40:41], v10 offset:20480
    ds_read_b64_tr_b16 v[42:43], v10 offset:21504
    buffer_load_dwordx4 v160, s[12:15], s27 offen offset:0  lds
    v_mfma_f32_32x32x16_bf16 v[80:95], a[148:151], v[24:27], v[80:95]
    ds_read_b64_tr_b16 v[44:45], v11 offset:20480
    ds_read_b64_tr_b16 v[46:47], v11 offset:21504
    v_mfma_f32_32x32x16_bf16 v[96:111], a[152:155], v[20:23], v[96:111]
    ds_read_b64_tr_b16 a[136:137], v12 offset:15360
    ds_read_b64_tr_b16 a[138:139], v12 offset:16128
    buffer_load_dwordx4 v161, s[12:15], s27 offen offset:1024  lds
    v_mfma_f32_32x32x16_bf16 v[112:127], a[152:155], v[24:27], v[112:127]
    ds_read_b64_tr_b16 a[140:141], v13 offset:15360
    ds_read_b64_tr_b16 a[142:143], v13 offset:16128
    s_add_u32 m0, s31, 53248
    s_add_u32 s30, s29, 786432
    v_mfma_f32_32x32x16_bf16 v[128:143], a[156:159], v[20:23], v[128:143]
    ds_read_b64_tr_b16 a[144:145], v14 offset:15360
    ds_read_b64_tr_b16 a[146:147], v14 offset:16128
    buffer_load_dwordx4 v164, s[16:19], s30 offen  lds
    v_mfma_f32_32x32x16_bf16 v[144:159], a[156:159], v[24:27], v[144:159]
    s_add_u32 m0, s57, 16384
    s_add_u32 s45, s45, 8192
    s_and_b32 s45, s45, 0xffff
    s_waitcnt lgkmcnt(6)
    v_mfma_f32_32x32x16_bf16 v[64:79], a[160:163], v[40:43], v[64:79]
    v_mfma_f32_32x32x16_bf16 v[80:95], a[160:163], v[44:47], v[80:95]
    s_waitcnt vmcnt(14) lgkmcnt(0)
    s_barrier
    ds_read_b64_tr_b16 v[20:21], v10 offset:24576
    ds_read_b64_tr_b16 v[22:23], v10 offset:25600
    v_mfma_f32_32x32x16_bf16 v[96:111], a[164:167], v[40:43], v[96:111]
    ds_read_b64_tr_b16 v[24:25], v11 offset:24576
    ds_read_b64_tr_b16 v[26:27], v11 offset:25600
    ds_read_b64_tr_b16 a[148:149], v12 offset:18432
    buffer_load_dwordx4 v163, s[32:35], s45 offen sc1 lds
    v_mfma_f32_32x32x16_bf16 v[112:127], a[164:167], v[44:47], v[112:127]
    ds_read_b64_tr_b16 a[150:151], v12 offset:19200
    ds_read_b64_tr_b16 a[152:153], v13 offset:18432
    ds_read_b64_tr_b16 a[154:155], v13 offset:19200
    v_mfma_f32_32x32x16_bf16 v[128:143], a[168:171], v[40:43], v[128:143]
    ds_read_b64_tr_b16 a[156:157], v14 offset:18432
    ds_read_b64_tr_b16 a[158:159], v14 offset:19200
    buffer_load_dwordx4 v163, s[32:35], s45 offen offset:1024 sc1 lds
    v_mfma_f32_32x32x16_bf16 v[144:159], a[168:171], v[44:47], v[144:159]
    s_add_u32 m0, s58, 43008
    s_waitcnt lgkmcnt(6)
    v_mfma_f32_32x32x16_bf16 v[64:79], a[172:175], v[20:23], v[64:79]
    ds_read_b64_tr_b16 v[40:41], v10 offset:28672
    ds_read_b64_tr_b16 v[42:43], v10 offset:29696
    buffer_load_dwordx4 v162, s[12:15], s27 offen offset:2048  lds
    v_mfma_f32_32x32x16_bf16 v[80:95], a[172:175], v[24:27], v[80:95]
    ds_read_b64_tr_b16 v[44:45], v11 offset:28672
    ds_read_b64_tr_b16 v[46:47], v11 offset:29696
    s_add_u32 m0, s31, 57344
    s_add_u32 s30, s29, 884736
    v_mfma_f32_32x32x16_bf16 v[96:111], a[176:179], v[20:23], v[96:111]
    ds_read_b64_tr_b16 a[160:161], v12 offset:21504
    ds_read_b64_tr_b16 a[162:163], v12 offset:22272
    buffer_load_dwordx4 v164, s[16:19], s30 offen  lds
    v_mfma_f32_32x32x16_bf16 v[112:127], a[176:179], v[24:27], v[112:127]
    ds_read_b64_tr_b16 a[164:165], v13 offset:21504
    ds_read_b64_tr_b16 a[166:167], v13 offset:22272
    s_add_u32 m0, s31, 61440
    s_add_u32 s30, s29, 983040
    v_mfma_f32_32x32x16_bf16 v[128:143], a[180:183], v[20:23], v[128:143]
    ds_read_b64_tr_b16 a[168:169], v14 offset:21504
    ds_read_b64_tr_b16 a[170:171], v14 offset:22272
    buffer_load_dwordx4 v164, s[16:19], s30 offen  lds
    v_mfma_f32_32x32x16_bf16 v[144:159], a[180:183], v[24:27], v[144:159]
    s_add_u32 m0, s57, 24576
    s_add_u32 s45, s45, 8192
    s_and_b32 s45, s45, 0xffff
    s_waitcnt lgkmcnt(6)
    v_mfma_f32_32x32x16_bf16 v[64:79], a[184:187], v[40:43], v[64:79]
    v_mfma_f32_32x32x16_bf16 v[80:95], a[184:187], v[44:47], v[80:95]
    s_waitcnt vmcnt(14) lgkmcnt(0)
    s_barrier
    ds_read_b64_tr_b16 v[20:21], v10 offset:0
    ds_read_b64_tr_b16 v[22:23], v10 offset:1024
    v_mfma_f32_32x32x16_bf16 v[96:111], a[188:191], v[40:43], v[96:111]
    ds_read_b64_tr_b16 v[24:25], v11 offset:0
    ds_read_b64_tr_b16 v[26:27], v11 offset:1024
    ds_read_b64_tr_b16 a[172:173], v12 offset:24576
    buffer_load_dwordx4 v163, s[32:35], s45 offen sc1 lds
    v_mfma_f32_32x32x16_bf16 v[112:127], a[188:191], v[44:47], v[112:127]
    ds_read_b64_tr_b16 a[174:175], v12 offset:25344
    ds_read_b64_tr_b16 a[176:177], v13 offset:24576
    ds_read_b64_tr_b16 a[178:179], v13 offset:25344
    v_mfma_f32_32x32x16_bf16 v[128:143], a[192:195], v[40:43], v[128:143]
    ds_read_b64_tr_b16 a[180:181], v14 offset:24576
    ds_read_b64_tr_b16 a[182:183], v14 offset:25344
    buffer_load_dwordx4 v163, s[32:35], s45 offen offset:1024 sc1 lds
    v_mfma_f32_32x32x16_bf16 v[144:159], a[192:195], v[44:47], v[144:159]
    s_add_u32 m0, s31, 32768
    s_add_u32 s30, s29, 294912
    s_waitcnt lgkmcnt(6)
    v_mfma_f32_32x32x16_bf16 v[64:79], a[196:199], v[20:23], v[64:79]
    ds_read_b64_tr_b16 v[40:41], v10 offset:4096
    ds_read_b64_tr_b16 v[42:43], v10 offset:5120
    buffer_load_dwordx4 v164, s[16:19], s30 offen  lds
    v_mfma_f32_32x32x16_bf16 v[80:95], a[196:199], v[24:27], v[80:95]
    ds_read_b64_tr_b16 v[44:45], v11 offset:4096
    ds_read_b64_tr_b16 v[46:47], v11 offset:5120
    s_add_u32 m0, s31, 36864
    s_add_u32 s30, s29, 393216
    v_mfma_f32_32x32x16_bf16 v[96:111], a[200:203], v[20:23], v[96:111]
    ds_read_b64_tr_b16 a[184:185], v12 offset:27648
    ds_read_b64_tr_b16 a[186:187], v12 offset:28416
    buffer_load_dwordx4 v164, s[16:19], s30 offen  lds
    v_mfma_f32_32x32x16_bf16 v[112:127], a[200:203], v[24:27], v[112:127]
    ds_read_b64_tr_b16 a[188:189], v13 offset:27648
    ds_read_b64_tr_b16 a[190:191], v13 offset:28416
    s_add_u32 m0, s31, 40960
    s_add_u32 s30, s29, 491520
    v_mfma_f32_32x32x16_bf16 v[128:143], a[204:207], v[20:23], v[128:143]
    ds_read_b64_tr_b16 a[192:193], v14 offset:27648
    ds_read_b64_tr_b16 a[194:195], v14 offset:28416
    buffer_load_dwordx4 v164, s[16:19], s30 offen  lds
    v_mfma_f32_32x32x16_bf16 v[144:159], a[204:207], v[24:27], v[144:159]
    s_add_u32 m0, s57, 0
    s_add_u32 s45, s45, 8192
    s_and_b32 s45, s45, 0xffff
    s_waitcnt lgkmcnt(6)
    v_mfma_f32_32x32x16_bf16 v[64:79], a[208:211], v[40:43], v[64:79]
    v_mfma_f32_32x32x16_bf16 v[80:95], a[208:211], v[44:47], v[80:95]
    s_waitcnt vmcnt(13) lgkmcnt(0)
    s_barrier
    ds_read_b64_tr_b16 v[20:21], v10 offset:8192
    ds_read_b64_tr_b16 v[22:23], v10 offset:9216
    v_mfma_f32_32x32x16_bf16 v[96:111], a[212:215], v[40:43], v[96:111]
    ds_read_b64_tr_b16 v[24:25], v11 offset:8192
    ds_read_b64_tr_b16 v[26:27], v11 offset:9216
    ds_read_b64_tr_b16 a[196:197], v12 offset:30720
    buffer_load_dwordx4 v163, s[32:35], s45 offen sc1 lds
    v_mfma_f32_32x32x16_bf16 v[112:127], a[212:215], v[44:47], v[112:127]
    ds_read_b64_tr_b16 a[198:199], v12 offset:31488
    ds_read_b64_tr_b16 a[200:201], v13 offset:30720
    ds_read_b64_tr_b16 a[202:203], v13 offset:31488
    v_mfma_f32_32x32x16_bf16 v[128:143], a[216:219], v[40:43], v[128:143]
    ds_read_b64_tr_b16 a[204:205], v14 offset:30720
    ds_read_b64_tr_b16 a[206:207], v14 offset:31488
    buffer_load_dwordx4 v163, s[32:35], s45 offen offset:1024 sc1 lds
    v_mfma_f32_32x32x16_bf16 v[144:159], a[216:219], v[44:47], v[144:159]
    s_add_u32 m0, s31, 65536
    s_add_u32 s30, s29, 1081344
    s_waitcnt lgkmcnt(6)
    v_mfma_f32_32x32x16_bf16 v[64:79], a[220:223], v[20:23], v[64:79]
    ds_read_b64_tr_b16 v[40:41], v10 offset:12288
    ds_read_b64_tr_b16 v[42:43], v10 offset:13312
    buffer_load_dwordx4 v164, s[16:19], s30 offen  lds
    v_mfma_f32_32x32x16_bf16 v[80:95], a[220:223], v[24:27], v[80:95]
    ds_read_b64_tr_b16 v[44:45], v11 offset:12288
    ds_read_b64_tr_b16 v[46:47], v11 offset:13312
    s_add_u32 m0, s31, 114688
    s_add_u32 s30, s29, 1277952
    v_mfma_f32_32x32x16_bf16 v[96:111], a[224:227], v[20:23], v[96:111]
    ds_read_b64_tr_b16 a[208:209], v12 offset:33792
    ds_read_b64_tr_b16 a[210:211], v12 offset:34560
    buffer_load_dwordx4 v164, s[16:19], s30 offen  lds
    v_mfma_f32_32x32x16_bf16 v[112:127], a[224:227], v[24:27], v[112:127]
    ds_read_b64_tr_b16 a[212:213], v13 offset:33792
    ds_read_b64_tr_b16 a[214:215], v13 offset:34560
    s_add_u32 m0, s31, 69632
    s_add_u32 s30, s29, 1179648
    v_mfma_f32_32x32x16_bf16 v[128:143], a[228:231], v[20:23], v[128:143]
    ds_read_b64_tr_b16 a[216:217], v14 offset:33792
    ds_read_b64_tr_b16 a[218:219], v14 offset:34560
    buffer_load_dwordx4 v164, s[16:19], s30 offen  lds
    v_mfma_f32_32x32x16_bf16 v[144:159], a[228:231], v[24:27], v[144:159]
    s_add_u32 m0, s57, 8192
    s_add_u32 s45, s45, 8192
    s_and_b32 s45, s45, 0xffff
    s_waitcnt lgkmcnt(6)
    v_mfma_f32_32x32x16_bf16 v[64:79], a[232:235], v[40:43], v[64:79]
    v_mfma_f32_32x32x16_bf16 v[80:95], a[232:235], v[44:47], v[80:95]
    s_waitcnt vmcnt(13) lgkmcnt(0)
    s_barrier
    ds_read_b64_tr_b16 v[20:21], v10 offset:16384
    ds_read_b64_tr_b16 v[22:23], v10 offset:17408
    v_mfma_f32_32x32x16_bf16 v[96:111], a[236:239], v[40:43], v[96:111]
    ds_read_b64_tr_b16 v[24:25], v11 offset:16384
    ds_read_b64_tr_b16 v[26:27], v11 offset:17408
    ds_read_b64_tr_b16 a[220:221], v12 offset:36864
    buffer_load_dwordx4 v163, s[32:35], s45 offen sc1 lds
    v_mfma_f32_32x32x16_bf16 v[112:127], a[236:239], v[44:47], v[112:127]
    ds_read_b64_tr_b16 a[222:223], v12 offset:37632
    ds_read_b64_tr_b16 a[224:225], v13 offset:36864
    ds_read_b64_tr_b16 a[226:227], v13 offset:37632
    v_mfma_f32_32x32x16_bf16 v[128:143], a[240:243], v[40:43], v[128:143]
    ds_read_b64_tr_b16 a[228:229], v14 offset:36864
    ds_read_b64_tr_b16 a[230:231], v14 offset:37632
    buffer_load_dwordx4 v163, s[32:35], s45 offen offset:1024 sc1 lds
    v_mfma_f32_32x32x16_bf16 v[144:159], a[240:243], v[44:47], v[144:159]
    s_add_u32 m0, s31, 118784
    s_mov_b32 s30, 1376256
    s_cmp_eq_u32 s49, 0
    s_cselect_b32 s30, s30, 16384
    s_add_u32 s30, s30, s28
    s_waitcnt lgkmcnt(6)
    v_mfma_f32_32x32x16_bf16 v[64:79], a[124:127], v[20:23], v[64:79]
    ds_read_b64_tr_b16 v[40:41], v10 offset:20480
    ds_read_b64_tr_b16 v[42:43], v10 offset:21504
    buffer_load_dwordx4 v164, s[16:19], s30 offen  lds
    v_mfma_f32_32x32x16_bf16 v[80:95], a[124:127], v[24:27], v[80:95]
    ds_read_b64_tr_b16 v[44:45], v11 offset:20480
    ds_read_b64_tr_b16 v[46:47], v11 offset:21504
    s_add_u32 m0, s31, 73728
    s_add_u32 s30, s29, 65536
    v_mfma_f32_32x32x16_bf16 v[96:111], a[128:131], v[20:23], v[96:111]
    ds_read_b64_tr_b16 a[232:233], v12 offset:39936
    ds_read_b64_tr_b16 a[234:235], v12 offset:40704
    buffer_load_dwordx4 v164, s[16:19], s30 offen  lds
    v_mfma_f32_32x32x16_bf16 v[112:127], a[128:131], v[24:27], v[112:127]
    ds_read_b64_tr_b16 a[236:237], v13 offset:39936
    ds_read_b64_tr_b16 a[238:239], v13 offset:40704
    s_add_u32 m0, s31, 122880
    s_add_u32 s30, s29, 262144
    v_mfma_f32_32x32x16_bf16 v[128:143], a[132:135], v[20:23], v[128:143]
    ds_read_b64_tr_b16 a[240:241], v14 offset:39936
    ds_read_b64_tr_b16 a[242:243], v14 offset:40704
    buffer_load_dwordx4 v164, s[16:19], s30 offen  lds
    v_mfma_f32_32x32x16_bf16 v[144:159], a[132:135], v[24:27], v[144:159]
    s_add_u32 m0, s57, 16384
    s_add_u32 s45, s45, 8192
    s_and_b32 s45, s45, 0xffff
    s_waitcnt lgkmcnt(6)
    v_mfma_f32_32x32x16_bf16 v[64:79], a[136:139], v[40:43], v[64:79]
    v_mfma_f32_32x32x16_bf16 v[80:95], a[136:139], v[44:47], v[80:95]
    s_waitcnt vmcnt(13) lgkmcnt(0)
    s_barrier
    ds_read_b64_tr_b16 v[20:21], v10 offset:24576
    ds_read_b64_tr_b16 v[22:23], v10 offset:25600
    v_mfma_f32_32x32x16_bf16 v[96:111], a[140:143], v[40:43], v[96:111]
    ds_read_b64_tr_b16 v[24:25], v11 offset:24576
    ds_read_b64_tr_b16 v[26:27], v11 offset:25600
    ds_read_b64_tr_b16 a[124:125], v12 offset:43008
    buffer_load_dwordx4 v163, s[32:35], s45 offen sc1 lds
    v_mfma_f32_32x32x16_bf16 v[112:127], a[140:143], v[44:47], v[112:127]
    ds_read_b64_tr_b16 a[126:127], v12 offset:43776
    ds_read_b64_tr_b16 a[128:129], v13 offset:43008
    ds_read_b64_tr_b16 a[130:131], v13 offset:43776
    v_mfma_f32_32x32x16_bf16 v[128:143], a[144:147], v[40:43], v[128:143]
    ds_read_b64_tr_b16 a[132:133], v14 offset:43008
    ds_read_b64_tr_b16 a[134:135], v14 offset:43776
    buffer_load_dwordx4 v163, s[32:35], s45 offen offset:1024 sc1 lds
    v_mfma_f32_32x32x16_bf16 v[144:159], a[144:147], v[44:47], v[144:159]
    s_add_u32 m0, s31, 77824
    s_add_u32 s30, s29, 163840
    s_waitcnt lgkmcnt(6)
    v_mfma_f32_32x32x16_bf16 v[64:79], a[148:151], v[20:23], v[64:79]
    ds_read_b64_tr_b16 v[40:41], v10 offset:28672
    ds_read_b64_tr_b16 v[42:43], v10 offset:29696
    buffer_load_dwordx4 v164, s[16:19], s30 offen  lds
    v_mfma_f32_32x32x16_bf16 v[80:95], a[148:151], v[24:27], v[80:95]
    ds_read_b64_tr_b16 v[44:45], v11 offset:28672
    ds_read_b64_tr_b16 v[46:47], v11 offset:29696
    s_add_u32 m0, s31, 126976
    s_add_u32 s30, s29, 360448
    v_mfma_f32_32x32x16_bf16 v[96:111], a[152:155], v[20:23], v[96:111]
    ds_read_b64_tr_b16 a[136:137], v12 offset:46080
    ds_read_b64_tr_b16 a[138:139], v12 offset:46848
    buffer_load_dwordx4 v164, s[16:19], s30 offen  lds
    v_mfma_f32_32x32x16_bf16 v[112:127], a[152:155], v[24:27], v[112:127]
    ds_read_b64_tr_b16 a[140:141], v13 offset:46080
    ds_read_b64_tr_b16 a[142:143], v13 offset:46848
    s_add_u32 m0, s31, 81920
    s_add_u32 s30, s29, 458752
    v_mfma_f32_32x32x16_bf16 v[128:143], a[156:159], v[20:23], v[128:143]
    ds_read_b64_tr_b16 a[144:145], v14 offset:46080
    ds_read_b64_tr_b16 a[146:147], v14 offset:46848
    buffer_load_dwordx4 v164, s[16:19], s30 offen  lds
    v_mfma_f32_32x32x16_bf16 v[144:159], a[156:159], v[24:27], v[144:159]
    s_waitcnt lgkmcnt(6)
    v_mfma_f32_32x32x16_bf16 v[64:79], a[160:163], v[40:43], v[64:79]
    v_mfma_f32_32x32x16_bf16 v[80:95], a[160:163], v[44:47], v[80:95]
    s_waitcnt vmcnt(7) lgkmcnt(0)
    s_barrier
    ds_read_b64_tr_b16 v[20:21], v10 offset:0
    ds_read_b64_tr_b16 v[22:23], v10 offset:1024
    v_mfma_f32_32x32x16_bf16 v[96:111], a[164:167], v[40:43], v[96:111]
    ds_read_b64_tr_b16 v[24:25], v11 offset:0
    ds_read_b64_tr_b16 v[26:27], v11 offset:1024
    buffer_load_dwordx4 v[200:203], v8, s[8:11], s46 offen offset:0 sc1
    v_mfma_f32_32x32x16_bf16 v[112:127], a[164:167], v[44:47], v[112:127]
    buffer_load_dwordx4 v[204:207], v8, s[8:11], s46 offen offset:512 sc1
    v_mfma_f32_32x32x16_bf16 v[128:143], a[168:171], v[40:43], v[128:143]
    buffer_load_dwordx4 v[196:199], v163, s[8:11], s0 offen sc1
    v_mfma_f32_32x32x16_bf16 v[144:159], a[168:171], v[44:47], v[144:159]
    s_add_u32 m0, s57, 24576
    s_add_u32 s45, s45, 8192
    s_and_b32 s45, s45, 0xffff
    buffer_load_dwordx4 v163, s[32:35], s45 offen sc1 lds
    s_waitcnt lgkmcnt(0)
    v_mfma_f32_32x32x16_bf16 v[64:79], a[172:175], v[20:23], v[64:79]
    ds_read_b64_tr_b16 v[40:41], v10 offset:4096
    ds_read_b64_tr_b16 v[42:43], v10 offset:5120
    buffer_load_dwordx4 v163, s[32:35], s45 offen offset:1024 sc1 lds
    ds_read_b64_tr_b16 a[24:25], v165 offset:32768
    ds_read_b64_tr_b16 a[26:27], v165 offset:33792
    v_mfma_f32_32x32x16_bf16 v[80:95], a[172:175], v[24:27], v[80:95]
    ds_read_b64_tr_b16 v[44:45], v11 offset:4096
    ds_read_b64_tr_b16 v[46:47], v11 offset:5120
    s_add_u32 m0, s31, 86016
    s_add_u32 s30, s29, 557056
    ds_read_b64_tr_b16 a[28:29], v165 offset:34816
    v_mfma_f32_32x32x16_bf16 v[96:111], a[176:179], v[20:23], v[96:111]
    buffer_load_dwordx4 v164, s[16:19], s30 offen  lds
    ds_read_b64_tr_b16 a[30:31], v165 offset:35840
    ds_read_b64_tr_b16 a[32:33], v165 offset:36864
    ds_read_b64_tr_b16 a[34:35], v165 offset:37888
    ds_read_b64_tr_b16 a[36:37], v165 offset:38912
    v_mfma_f32_32x32x16_bf16 v[112:127], a[176:179], v[24:27], v[112:127]
    s_add_u32 m0, s31, 131072
    s_add_u32 s30, s29, 655360
    buffer_load_dwordx4 v164, s[16:19], s30 offen  lds
    ds_read_b64_tr_b16 a[38:39], v165 offset:39936
    v_mfma_f32_32x32x16_bf16 v[128:143], a[180:183], v[20:23], v[128:143]
    s_add_u32 m0, s31, 135168
    s_add_u32 s30, s29, 753664
    buffer_load_dwordx4 v164, s[16:19], s30 offen  lds
    ds_read_b64_tr_b16 a[40:41], v165 offset:40960
    ds_read_b64_tr_b16 a[42:43], v165 offset:41984
    v_mfma_f32_32x32x16_bf16 v[144:159], a[180:183], v[24:27], v[144:159]
    s_add_u32 m0, s31, 90112
    s_add_u32 s30, s29, 851968
    buffer_load_dwordx4 v164, s[16:19], s30 offen  lds
    ds_read_b64_tr_b16 a[44:45], v165 offset:43008
    s_waitcnt lgkmcnt(9)
    v_mfma_f32_32x32x16_bf16 v[64:79], a[184:187], v[40:43], v[64:79]
    s_add_u32 m0, s31, 139264
    s_add_u32 s30, s29, 1048576
    v_mfma_f32_32x32x16_bf16 v[80:95], a[184:187], v[44:47], v[80:95]
    s_waitcnt vmcnt(17) lgkmcnt(0)
    s_barrier
    ds_read_b64_tr_b16 v[20:21], v10 offset:8192
    ds_read_b64_tr_b16 v[22:23], v10 offset:9216
    ds_read_b64_tr_b16 a[46:47], v165 offset:44032
    v_mfma_f32_32x32x16_bf16 v[96:111], a[188:191], v[40:43], v[96:111]
    ds_read_b64_tr_b16 v[24:25], v11 offset:8192
    ds_read_b64_tr_b16 v[26:27], v11 offset:9216
    buffer_load_dwordx4 v164, s[16:19], s30 offen  lds
    ds_read_b64_tr_b16 a[48:49], v165 offset:45056
    ds_read_b64_tr_b16 a[50:51], v165 offset:46080
    v_mfma_f32_32x32x16_bf16 v[112:127], a[188:191], v[44:47], v[112:127]
    s_add_u32 m0, s31, 94208
    s_add_u32 s30, s29, 950272
    ds_read_b64_tr_b16 a[52:53], v165 offset:47104
    ds_read_b64_tr_b16 a[54:55], v165 offset:48128
    ds_read_b64_tr_b16 a[56:57], v165 offset:49152
    v_mfma_f32_32x32x16_bf16 v[128:143], a[192:195], v[40:43], v[128:143]
    ds_read_b64_tr_b16 a[58:59], v165 offset:50176
    ds_read_b64_tr_b16 a[60:61], v165 offset:51200
    ds_read_b64_tr_b16 a[62:63], v165 offset:52224
    ds_read_b64_tr_b16 a[64:65], v165 offset:53248
    ds_read_b64_tr_b16 a[66:67], v165 offset:54272
PG9:
    s_cbranch_execz WARM2_0_ret
    ds_read_b64_tr_b16 a[68:69], v165 offset:55296
    v_mfma_f32_32x32x16_bf16 v[144:159], a[192:195], v[44:47], v[144:159]
    buffer_load_dwordx4 v164, s[16:19], s30 offen  lds
    ds_read_b64_tr_b16 a[70:71], v165 offset:56320
    ds_read_b64_tr_b16 a[72:73], v165 offset:57344
    ds_read_b64_tr_b16 a[74:75], v165 offset:58368
    s_waitcnt lgkmcnt(14)
    v_mfma_f32_32x32x16_bf16 v[64:79], a[196:199], v[20:23], v[64:79]
    ds_read_b64_tr_b16 v[40:41], v10 offset:12288
    ds_read_b64_tr_b16 v[42:43], v10 offset:13312
    s_add_u32 m0, s31, 98304
    s_add_u32 s30, s29, 1245184
    ds_read_b64_tr_b16 a[76:77], v165 offset:59392
    ds_read_b64_tr_b16 a[78:79], v165 offset:60416
    v_mfma_f32_32x32x16_bf16 v[80:95], a[196:199], v[24:27], v[80:95]
    ds_read_b64_tr_b16 v[44:45], v11 offset:12288
    ds_read_b64_tr_b16 v[46:47], v11 offset:13312
    ds_read_b64_tr_b16 a[80:81], v165 offset:61440
    ds_read_b64_tr_b16 a[82:83], v165 offset:62464
    ds_read_b64_tr_b16 a[84:85], v165 offset:63488
    v_mfma_f32_32x32x16_bf16 v[96:111], a[200:203], v[20:23], v[96:111]
    ds_read_b64_tr_b16 a[86:87], v165 offset:64512
    ds_read_b64_tr_b16 a[88:89], v4 offset:0
    ds_read_b64_tr_b16 a[90:91], v4 offset:1024
    ds_read_b64_tr_b16 a[92:93], v4 offset:2048
    ds_read_b64_tr_b16 a[94:95], v4 offset:3072
    ds_read_b64_tr_b16 a[96:97], v4 offset:4096
    v_mfma_f32_32x32x16_bf16 v[112:127], a[200:203], v[24:27], v[112:127]
    buffer_load_dwordx4 v164, s[16:19], s30 offen  lds
    ds_read_b64_tr_b16 a[98:99], v4 offset:5120
    ds_read_b64_tr_b16 a[100:101], v4 offset:6144
    ds_read_b64_tr_b16 a[102:103], v4 offset:7168
    v_mfma_f32_32x32x16_bf16 v[128:143], a[204:207], v[20:23], v[128:143]
    s_add_u32 m0, s31, 143360
    s_add_u32 s30, s29, 1146880
    ds_read_b64_tr_b16 a[104:105], v5 offset:0
    ds_read_b64_tr_b16 a[106:107], v5 offset:1024
    ds_read_b64_tr_b16 a[108:109], v5 offset:2048
    ds_read_b64_tr_b16 a[110:111], v5 offset:3072
    v_mfma_f32_32x32x16_bf16 v[144:159], a[204:207], v[24:27], v[144:159]
    ds_read_b64_tr_b16 a[112:113], v5 offset:4096
    ds_read_b64_tr_b16 a[114:115], v5 offset:5120
    ds_read_b64_tr_b16 a[116:117], v5 offset:6144
    ds_read_b64_tr_b16 a[118:119], v5 offset:7168
    s_waitcnt lgkmcnt(14)
    v_mfma_f32_32x32x16_bf16 v[64:79], a[208:211], v[40:43], v[64:79]
    v_mfma_f32_32x32x16_bf16 v[80:95], a[208:211], v[44:47], v[80:95]
    s_waitcnt vmcnt(7) lgkmcnt(0)
    s_barrier
    ds_read_b64_tr_b16 v[168:169], v10 offset:16384
    ds_read_b64_tr_b16 v[170:171], v10 offset:17408
    v_mfma_f32_32x32x16_bf16 v[96:111], a[212:215], v[40:43], v[96:111]
    ds_read_b64_tr_b16 v[172:173], v11 offset:16384
    ds_read_b64_tr_b16 v[174:175], v11 offset:17408
    ds_read_b64_tr_b16 v[176:177], v10 offset:20480
    ds_read_b64_tr_b16 v[178:179], v10 offset:21504
    buffer_load_dwordx4 v164, s[16:19], s30 offen  lds
    v_mfma_f32_32x32x16_bf16 v[112:127], a[212:215], v[44:47], v[112:127]
    ds_read_b64_tr_b16 v[180:181], v11 offset:20480
    ds_read_b64_tr_b16 v[182:183], v11 offset:21504
    ds_read_b64_tr_b16 v[184:185], v10 offset:24576
    ds_read_b64_tr_b16 v[186:187], v10 offset:25600
    s_add_u32 m0, s31, 147456
    s_add_u32 s30, s29, 32768
    v_mfma_f32_32x32x16_bf16 v[128:143], a[216:219], v[40:43], v[128:143]
    ds_read_b64_tr_b16 v[188:189], v11 offset:24576
    ds_read_b64_tr_b16 v[190:191], v11 offset:25600
    ds_read_b64_tr_b16 v[236:237], v10 offset:28672
    ds_read_b64_tr_b16 v[238:239], v10 offset:29696
    buffer_load_dwordx4 v164, s[16:19], s30 offen  lds
    v_mfma_f32_32x32x16_bf16 v[144:159], a[216:219], v[44:47], v[144:159]
    ds_read_b64_tr_b16 v[240:241], v11 offset:28672
    ds_read_b64_tr_b16 v[242:243], v11 offset:29696
    s_add_u32 m0, s31, 102400
    s_add_u32 s30, s29, 1343488
    s_waitcnt lgkmcnt(12)
    v_mfma_f32_32x32x16_bf16 v[64:79], a[220:223], v[168:171], v[64:79]
    buffer_load_dwordx4 v164, s[16:19], s30 offen  lds
    v_xor_b32 v2, s44, v203
    v_bitop3_b32 v2, v207, s44, v2 bitop3:0xbe
    v_bitop3_b32 v2, v199, s44, v2 bitop3:0xbe
    v_mfma_f32_32x32x16_bf16 v[80:95], a[220:223], v[172:175], v[80:95]
    v_cmp_ne_u32 vcc, 0, v2
    v_mov_b32 v208, v196
    v_mov_b32 v212, v197
    v_mov_b32 v216, v198
    s_waitcnt lgkmcnt(8)
    v_mfma_f32_32x32x16_bf16 v[64:79], a[232:235], v[176:179], v[64:79]
    v_perm_b32 v228, v202, v202, v220
    v_and_b32 v60, 0xffff0000, v202
    v_perm_b32 v232, v206, v206, v220
    v_and_b32 v62, 0xffff0000, v206
    v_mul_f32 v60, v60, v60
    v_mfma_f32_32x32x16_bf16 v[80:95], a[232:235], v[180:183], v[80:95]
    s_waitcnt vmcnt(10) lgkmcnt(0)
    s_barrier
    s_add_u32 m0, s31, 151552
    s_add_u32 s30, s29, 131072
    buffer_load_dwordx4 v164, s[16:19], s30 offen  lds
    v_mfma_f32_32x32x16_bf16 v[64:79], a[124:127], v[184:187], v[64:79]
    s_add_u32 m0, s31, 106496
    s_add_u32 s30, s29, 1015808
    buffer_load_dwordx4 v164, s[16:19], s30 offen  lds
    v_mul_f32 v62, v62, v62
    v_mfma_f32_32x32x16_bf16 v[80:95], a[124:127], v[188:191], v[80:95]
    s_add_u32 m0, s31, 110592
    s_add_u32 s30, s29, 1114112
    buffer_load_dwordx4 v164, s[16:19], s30 offen  lds
    v_mfma_f32_32x32x16_bf16 v[64:79], a[136:139], v[236:239], v[64:79]
    s_add_u32 m0, s31, 155648
    s_add_u32 s30, s29, 1212416
    buffer_load_dwordx4 v164, s[16:19], s30 offen  lds
    v_mfma_f32_32x32x16_bf16 v[80:95], a[136:139], v[240:243], v[80:95]
    s_add_u32 m0, s31, 159744
    s_add_u32 s30, s29, 1310720
    buffer_load_dwordx4 v164, s[16:19], s30 offen  lds
    s_cbranch_vccnz G1_slow
G1_tagok:
    v_mfma_f32_32x32x16_bf16 v[64:79], v[208:211], v[228:231], v[64:79]
    s_add_u32 m0, s31, 0
    s_add_u32 s30, s29, 229376
    buffer_load_dwordx4 v164, s[16:19], s30 offen  lds
    v_mfma_f32_32x32x16_bf16 v[80:95], v[208:211], v[232:235], v[80:95]
    s_add_u32 m0, s31, 4096
    s_add_u32 s30, s29, 327680
    buffer_load_dwordx4 v164, s[16:19], s30 offen  lds
    v_mov_b32 v18, s44
    s_add_u32 s4, s52, 0
    s_add_u32 s5, s4, 88064
    s_cmp_lt_u32 s61, 29
    s_cselect_b32 s0, s4, 268435456
    s_cselect_b32 s1, s5, 268435456
    s_add_u32 m0, s31, 8192
    s_add_u32 s30, s29, 425984
    buffer_load_dwordx4 v164, s[16:19], s30 offen  lds
    s_add_u32 m0, s31, 12288
    s_add_u32 s30, s29, 524288
    buffer_load_dwordx4 v164, s[16:19], s30 offen  lds
    v_pk_mul_f32 v[20:21], v[64:65], v[64:65]
    v_pk_mul_f32 v[22:23], v[66:67], v[66:67]
    v_pk_mul_f32 v[24:25], v[72:73], v[72:73]
    v_pk_mul_f32 v[26:27], v[74:75], v[74:75]
    v_pk_fma_f32 v[20:21], v[20:21], v[200:201], v[200:201] op_sel:[0,1,0] op_sel_hi:[1,1,0]
    v_pk_fma_f32 v[22:23], v[22:23], v[200:201], v[200:201] op_sel:[0,1,0] op_sel_hi:[1,1,0]
    v_pk_fma_f32 v[24:25], v[24:25], v[200:201], v[200:201] op_sel:[0,1,0] op_sel_hi:[1,1,0]
    v_pk_fma_f32 v[26:27], v[26:27], v[200:201], v[200:201] op_sel:[0,1,0] op_sel_hi:[1,1,0]
    v_pk_mul_f32 v[20:21], v[20:21], v[64:65]
    v_pk_mul_f32 v[22:23], v[22:23], v[66:67]
    v_pk_mul_f32 v[24:25], v[24:25], v[72:73]
    v_pk_mul_f32 v[26:27], v[26:27], v[74:75]
    v_pk_mul_f32 v[28:29], v[64:65], v[68:69]
    v_pk_mul_f32 v[30:31], v[66:67], v[70:71]
    v_pk_mul_f32 v[32:33], v[72:73], v[76:77]
    v_pk_mul_f32 v[34:35], v[74:75], v[78:79]
    v_mfma_f32_32x32x16_bf16 v[96:111], v[212:215], v[228:231], v[96:111]
    v_exp_f32 v20, v20
    s_add_u32 m0, s31, 16384
    s_add_u32 s30, s29, 622592
    buffer_load_dwordx4 v164, s[16:19], s30 offen  lds
    v_exp_f32 v21, v21
    v_exp_f32 v22, v22
    v_mfma_f32_32x32x16_bf16 v[112:127], v[212:215], v[232:235], v[112:127]
    v_exp_f32 v23, v23
    v_exp_f32 v24, v24
    v_exp_f32 v25, v25
    v_exp_f32 v26, v26
    v_exp_f32 v27, v27
    v_pk_fma_f32 v[20:21], v[20:21], v[60:61], v[60:61] op_sel_hi:[1,0,0]
    v_pk_fma_f32 v[22:23], v[22:23], v[60:61], v[60:61] op_sel_hi:[1,0,0]
    v_pk_fma_f32 v[24:25], v[24:25], v[60:61], v[60:61] op_sel_hi:[1,0,0]
    v_pk_fma_f32 v[26:27], v[26:27], v[60:61], v[60:61] op_sel_hi:[1,0,0]
    v_mfma_f32_32x32x16_bf16 v[96:111], a[224:227], v[168:171], v[96:111]
    v_rcp_f32 v20, v20
    v_rcp_f32 v21, v21
    v_rcp_f32 v22, v22
    v_mfma_f32_32x32x16_bf16 v[112:127], a[224:227], v[172:175], v[112:127]
    v_rcp_f32 v23, v23
    v_rcp_f32 v24, v24
    v_rcp_f32 v25, v25
    v_rcp_f32 v26, v26
    v_rcp_f32 v27, v27
    v_pk_mul_f32 v[20:21], v[20:21], v[28:29]
    v_pk_mul_f32 v[22:23], v[22:23], v[30:31]
    v_pk_mul_f32 v[24:25], v[24:25], v[32:33]
    v_pk_mul_f32 v[26:27], v[26:27], v[34:35]
    v_mfma_f32_32x32x16_bf16 v[96:111], a[236:239], v[176:179], v[96:111]
    v_cvt_pk_bf16_f32 v52, v20, v21
    v_cvt_pk_bf16_f32 v53, v22, v23
    v_cvt_pk_bf16_f32 v54, v24, v25
    v_cvt_pk_bf16_f32 v55, v26, v27
    buffer_store_dwordx4 v[52:55], v163, s[8:11], s0 offen sc1
    s_add_u32 m0, s31, 20480
    s_add_u32 s30, s29, 720896
    buffer_load_dwordx4 v164, s[16:19], s30 offen  lds
    v_pk_mul_f32 v[36:37], v[80:81], v[80:81]
    v_pk_mul_f32 v[38:39], v[82:83], v[82:83]
    v_pk_mul_f32 v[40:41], v[88:89], v[88:89]
    v_pk_mul_f32 v[42:43], v[90:91], v[90:91]
    v_pk_fma_f32 v[36:37], v[36:37], v[204:205], v[204:205] op_sel:[0,1,0] op_sel_hi:[1,1,0]
    v_pk_fma_f32 v[38:39], v[38:39], v[204:205], v[204:205] op_sel:[0,1,0] op_sel_hi:[1,1,0]
    v_pk_fma_f32 v[40:41], v[40:41], v[204:205], v[204:205] op_sel:[0,1,0] op_sel_hi:[1,1,0]
    v_pk_fma_f32 v[42:43], v[42:43], v[204:205], v[204:205] op_sel:[0,1,0] op_sel_hi:[1,1,0]
    v_pk_mul_f32 v[36:37], v[36:37], v[80:81]
    v_pk_mul_f32 v[38:39], v[38:39], v[82:83]
    v_pk_mul_f32 v[40:41], v[40:41], v[88:89]
    v_pk_mul_f32 v[42:43], v[42:43], v[90:91]
    v_pk_mul_f32 v[44:45], v[80:81], v[84:85]
    v_pk_mul_f32 v[46:47], v[82:83], v[86:87]
    v_pk_mul_f32 v[48:49], v[88:89], v[92:93]
    v_pk_mul_f32 v[50:51], v[90:91], v[94:95]
    v_mfma_f32_32x32x16_bf16 v[112:127], a[236:239], v[180:183], v[112:127]
    v_exp_f32 v36, v36
    s_add_u32 m0, s31, 24576
    s_add_u32 s30, s29, 819200
    buffer_load_dwordx4 v164, s[16:19], s30 offen  lds
    v_exp_f32 v37, v37
    v_exp_f32 v38, v38
    v_mfma_f32_32x32x16_bf16 v[96:111], a[128:131], v[184:187], v[96:111]
    v_exp_f32 v39, v39
    v_exp_f32 v40, v40
    v_exp_f32 v41, v41
    v_exp_f32 v42, v42
    v_exp_f32 v43, v43
    v_pk_fma_f32 v[36:37], v[36:37], v[62:63], v[62:63] op_sel_hi:[1,0,0]
    v_pk_fma_f32 v[38:39], v[38:39], v[62:63], v[62:63] op_sel_hi:[1,0,0]
    v_pk_fma_f32 v[40:41], v[40:41], v[62:63], v[62:63] op_sel_hi:[1,0,0]
    v_pk_fma_f32 v[42:43], v[42:43], v[62:63], v[62:63] op_sel_hi:[1,0,0]
    v_mfma_f32_32x32x16_bf16 v[112:127], a[128:131], v[188:191], v[112:127]
    v_rcp_f32 v36, v36
    v_rcp_f32 v37, v37
    v_rcp_f32 v38, v38
    v_mfma_f32_32x32x16_bf16 v[96:111], a[140:143], v[236:239], v[96:111]
    v_rcp_f32 v39, v39
    v_rcp_f32 v40, v40
    v_rcp_f32 v41, v41
    v_rcp_f32 v42, v42
    v_rcp_f32 v43, v43
    v_pk_mul_f32 v[36:37], v[36:37], v[44:45]
    v_pk_mul_f32 v[38:39], v[38:39], v[46:47]
    v_pk_mul_f32 v[40:41], v[40:41], v[48:49]
    v_pk_mul_f32 v[42:43], v[42:43], v[50:51]
    v_mfma_f32_32x32x16_bf16 v[112:127], a[140:143], v[240:243], v[112:127]
    v_cvt_pk_bf16_f32 v56, v36, v37
    v_cvt_pk_bf16_f32 v57, v38, v39
    v_cvt_pk_bf16_f32 v58, v40, v41
    v_cvt_pk_bf16_f32 v59, v42, v43
    buffer_store_dwordx4 v[56:59], v163, s[8:11], s1 offen sc1
    s_add_u32 s4, s52, 29696
    s_add_u32 s5, s4, 88064
    s_cmp_lt_u32 s61, 29
    s_cselect_b32 s0, s4, 268435456
    s_cselect_b32 s1, s5, 268435456
    s_add_u32 m0, s31, 28672
    s_add_u32 s30, s29, 917504
    buffer_load_dwordx4 v164, s[16:19], s30 offen  lds
    v_pk_mul_f32 v[20:21], v[96:97], v[96:97]
    v_pk_mul_f32 v[22:23], v[98:99], v[98:99]
    v_pk_mul_f32 v[24:25], v[104:105], v[104:105]
    v_pk_mul_f32 v[26:27], v[106:107], v[106:107]
    v_pk_fma_f32 v[20:21], v[20:21], v[200:201], v[200:201] op_sel:[0,1,0] op_sel_hi:[1,1,0]
    v_pk_fma_f32 v[22:23], v[22:23], v[200:201], v[200:201] op_sel:[0,1,0] op_sel_hi:[1,1,0]
    v_pk_fma_f32 v[24:25], v[24:25], v[200:201], v[200:201] op_sel:[0,1,0] op_sel_hi:[1,1,0]
    v_pk_fma_f32 v[26:27], v[26:27], v[200:201], v[200:201] op_sel:[0,1,0] op_sel_hi:[1,1,0]
    v_pk_mul_f32 v[20:21], v[20:21], v[96:97]
    v_pk_mul_f32 v[22:23], v[22:23], v[98:99]
    v_pk_mul_f32 v[24:25], v[24:25], v[104:105]
    v_pk_mul_f32 v[26:27], v[26:27], v[106:107]
    v_pk_mul_f32 v[28:29], v[96:97], v[100:101]
    v_pk_mul_f32 v[30:31], v[98:99], v[102:103]
    v_pk_mul_f32 v[32:33], v[104:105], v[108:109]
    v_pk_mul_f32 v[34:35], v[106:107], v[110:111]
    v_mfma_f32_32x32x16_bf16 v[128:143], v[216:219], v[228:231], v[128:143]
    v_exp_f32 v20, v20
    v_exp_f32 v21, v21
    v_exp_f32 v22, v22
    v_mfma_f32_32x32x16_bf16 v[144:159], v[216:219], v[232:235], v[144:159]
    v_exp_f32 v23, v23
    v_exp_f32 v24, v24
    v_exp_f32 v25, v25
    v_exp_f32 v26, v26
    v_exp_f32 v27, v27
    v_pk_fma_f32 v[20:21], v[20:21], v[60:61], v[60:61] op_sel_hi:[1,0,0]
    v_pk_fma_f32 v[22:23], v[22:23], v[60:61], v[60:61] op_sel_hi:[1,0,0]
    v_pk_fma_f32 v[24:25], v[24:25], v[60:61], v[60:61] op_sel_hi:[1,0,0]
    v_pk_fma_f32 v[26:27], v[26:27], v[60:61], v[60:61] op_sel_hi:[1,0,0]
    v_mfma_f32_32x32x16_bf16 v[128:143], a[228:231], v[168:171], v[128:143]
    v_rcp_f32 v20, v20
    v_rcp_f32 v21, v21
    v_rcp_f32 v22, v22
    v_mfma_f32_32x32x16_bf16 v[144:159], a[228:231], v[172:175], v[144:159]
    v_rcp_f32 v23, v23
    v_rcp_f32 v24, v24
    v_rcp_f32 v25, v25
    v_rcp_f32 v26, v26
    v_rcp_f32 v27, v27
    v_pk_mul_f32 v[20:21], v[20:21], v[28:29]
    v_pk_mul_f32 v[22:23], v[22:23], v[30:31]
    v_pk_mul_f32 v[24:25], v[24:25], v[32:33]
    v_pk_mul_f32 v[26:27], v[26:27], v[34:35]
    v_mfma_f32_32x32x16_bf16 v[128:143], a[240:243], v[176:179], v[128:143]
    v_cvt_pk_bf16_f32 v52, v20, v21
    v_cvt_pk_bf16_f32 v53, v22, v23
    v_cvt_pk_bf16_f32 v54, v24, v25
    v_cvt_pk_bf16_f32 v55, v26, v27
    buffer_store_dwordx4 v[52:55], v163, s[8:11], s0 offen sc1
    v_pk_mul_f32 v[36:37], v[112:113], v[112:113]
    v_pk_mul_f32 v[38:39], v[114:115], v[114:115]
    v_pk_mul_f32 v[40:41], v[120:121], v[120:121]
    v_pk_mul_f32 v[42:43], v[122:123], v[122:123]
    v_pk_fma_f32 v[36:37], v[36:37], v[204:205], v[204:205] op_sel:[0,1,0] op_sel_hi:[1,1,0]
    v_pk_fma_f32 v[38:39], v[38:39], v[204:205], v[204:205] op_sel:[0,1,0] op_sel_hi:[1,1,0]
    v_pk_fma_f32 v[40:41], v[40:41], v[204:205], v[204:205] op_sel:[0,1,0] op_sel_hi:[1,1,0]
    v_pk_fma_f32 v[42:43], v[42:43], v[204:205], v[204:205] op_sel:[0,1,0] op_sel_hi:[1,1,0]
    v_pk_mul_f32 v[36:37], v[36:37], v[112:113]
    v_pk_mul_f32 v[38:39], v[38:39], v[114:115]
    v_pk_mul_f32 v[40:41], v[40:41], v[120:121]
    v_pk_mul_f32 v[42:43], v[42:43], v[122:123]
    v_pk_mul_f32 v[44:45], v[112:113], v[116:117]
    v_pk_mul_f32 v[46:47], v[114:115], v[118:119]
    v_pk_mul_f32 v[48:49], v[120:121], v[124:125]
    v_pk_mul_f32 v[50:51], v[122:123], v[126:127]
    v_mfma_f32_32x32x16_bf16 v[144:159], a[240:243], v[180:183], v[144:159]
    v_exp_f32 v36, v36
    v_exp_f32 v37, v37
    v_exp_f32 v38, v38
    v_mfma_f32_32x32x16_bf16 v[128:143], a[132:135], v[184:187], v[128:143]
    v_exp_f32 v39, v39
    v_exp_f32 v40, v40
    v_exp_f32 v41, v41
    v_exp_f32 v42, v42
    v_exp_f32 v43, v43
    v_pk_fma_f32 v[36:37], v[36:37], v[62:63], v[62:63] op_sel_hi:[1,0,0]
    v_pk_fma_f32 v[38:39], v[38:39], v[62:63], v[62:63] op_sel_hi:[1,0,0]
    v_pk_fma_f32 v[40:41], v[40:41], v[62:63], v[62:63] op_sel_hi:[1,0,0]
    v_pk_fma_f32 v[42:43], v[42:43], v[62:63], v[62:63] op_sel_hi:[1,0,0]
    v_mfma_f32_32x32x16_bf16 v[144:159], a[132:135], v[188:191], v[144:159]
    v_rcp_f32 v36, v36
    v_rcp_f32 v37, v37
    v_rcp_f32 v38, v38
    v_mfma_f32_32x32x16_bf16 v[128:143], a[144:147], v[236:239], v[128:143]
    v_rcp_f32 v39, v39
    v_rcp_f32 v40, v40
    v_rcp_f32 v41, v41
    v_rcp_f32 v42, v42
    v_rcp_f32 v43, v43
    v_pk_mul_f32 v[36:37], v[36:37], v[44:45]
    v_pk_mul_f32 v[38:39], v[38:39], v[46:47]
    v_pk_mul_f32 v[40:41], v[40:41], v[48:49]
    v_pk_mul_f32 v[42:43], v[42:43], v[50:51]
    v_mfma_f32_32x32x16_bf16 v[144:159], a[144:147], v[240:243], v[144:159]
    v_cvt_pk_bf16_f32 v56, v36, v37
    v_cvt_pk_bf16_f32 v57, v38, v39
    v_cvt_pk_bf16_f32 v58, v40, v41
    v_cvt_pk_bf16_f32 v59, v42, v43
    s_waitcnt vmcnt(2)
    v_add_u32 v3, 1, v18
    s_mov_b64 exec, 1
    buffer_store_dword v3, v19, s[8:11], s40 offen
    buffer_store_dword v3, v19, s[8:11], s41 offen sc1
    s_mov_b64 exec, -1
    buffer_store_dwordx4 v[56:59], v163, s[8:11], s1 offen sc1
    s_add_u32 s4, s52, 59392
    s_add_u32 s5, s4, 88064
    s_cmp_lt_u32 s61, 28
    s_cselect_b32 s0, s4, 268435456
    s_cselect_b32 s1, s5, 268435456
    v_pk_mul_f32 v[20:21], v[128:129], v[128:129]
    v_pk_mul_f32 v[22:23], v[130:131], v[130:131]
    v_pk_mul_f32 v[24:25], v[136:137], v[136:137]
    v_pk_mul_f32 v[26:27], v[138:139], v[138:139]
    v_pk_fma_f32 v[20:21], v[20:21], v[200:201], v[200:201] op_sel:[0,1,0] op_sel_hi:[1,1,0]
    v_pk_fma_f32 v[22:23], v[22:23], v[200:201], v[200:201] op_sel:[0,1,0] op_sel_hi:[1,1,0]
    v_pk_fma_f32 v[24:25], v[24:25], v[200:201], v[200:201] op_sel:[0,1,0] op_sel_hi:[1,1,0]
    v_pk_fma_f32 v[26:27], v[26:27], v[200:201], v[200:201] op_sel:[0,1,0] op_sel_hi:[1,1,0]
    v_pk_mul_f32 v[20:21], v[20:21], v[128:129]
    v_pk_mul_f32 v[22:23], v[22:23], v[130:131]
    v_pk_mul_f32 v[24:25], v[24:25], v[136:137]
    v_pk_mul_f32 v[26:27], v[26:27], v[138:139]
    v_pk_mul_f32 v[28:29], v[128:129], v[132:133]
    v_pk_mul_f32 v[30:31], v[130:131], v[134:135]
    v_pk_mul_f32 v[32:33], v[136:137], v[140:141]
    v_pk_mul_f32 v[34:35], v[138:139], v[142:143]
    v_exp_f32 v20, v20
    v_exp_f32 v21, v21
    v_exp_f32 v22, v22
    v_exp_f32 v23, v23
    v_exp_f32 v24, v24
    v_exp_f32 v25, v25
    v_exp_f32 v26, v26
    v_exp_f32 v27, v27
    v_pk_fma_f32 v[20:21], v[20:21], v[60:61], v[60:61] op_sel_hi:[1,0,0]
    v_pk_fma_f32 v[22:23], v[22:23], v[60:61], v[60:61] op_sel_hi:[1,0,0]
    v_pk_fma_f32 v[24:25], v[24:25], v[60:61], v[60:61] op_sel_hi:[1,0,0]
    v_pk_fma_f32 v[26:27], v[26:27], v[60:61], v[60:61] op_sel_hi:[1,0,0]
    v_rcp_f32 v20, v20
    v_rcp_f32 v21, v21
    v_rcp_f32 v22, v22
    v_rcp_f32 v23, v23
    v_rcp_f32 v24, v24
    v_rcp_f32 v25, v25
    v_rcp_f32 v26, v26
    v_rcp_f32 v27, v27
    v_pk_mul_f32 v[20:21], v[20:21], v[28:29]
    v_pk_mul_f32 v[22:23], v[22:23], v[30:31]
    v_pk_mul_f32 v[24:25], v[24:25], v[32:33]
    v_pk_mul_f32 v[26:27], v[26:27], v[34:35]
    v_cvt_pk_bf16_f32 v52, v20, v21
    v_cvt_pk_bf16_f32 v53, v22, v23
    v_cvt_pk_bf16_f32 v54, v24, v25
    v_cvt_pk_bf16_f32 v55, v26, v27
    global_load_dword v17, v16, s[42:43] sc1
    buffer_store_dwordx4 v[52:55], v163, s[8:11], s0 offen sc1
    v_pk_mul_f32 v[36:37], v[144:145], v[144:145]
    v_pk_mul_f32 v[38:39], v[146:147], v[146:147]
    v_pk_mul_f32 v[40:41], v[152:153], v[152:153]
    v_pk_mul_f32 v[42:43], v[154:155], v[154:155]
    v_pk_fma_f32 v[36:37], v[36:37], v[204:205], v[204:205] op_sel:[0,1,0] op_sel_hi:[1,1,0]
    v_pk_fma_f32 v[38:39], v[38:39], v[204:205], v[204:205] op_sel:[0,1,0] op_sel_hi:[1,1,0]
    v_pk_fma_f32 v[40:41], v[40:41], v[204:205], v[204:205] op_sel:[0,1,0] op_sel_hi:[1,1,0]
    v_pk_fma_f32 v[42:43], v[42:43], v[204:205], v[204:205] op_sel:[0,1,0] op_sel_hi:[1,1,0]
    v_pk_mul_f32 v[36:37], v[36:37], v[144:145]
    v_pk_mul_f32 v[38:39], v[38:39], v[146:147]
    v_pk_mul_f32 v[40:41], v[40:41], v[152:153]
    v_pk_mul_f32 v[42:43], v[42:43], v[154:155]
    v_pk_mul_f32 v[44:45], v[144:145], v[148:149]
    v_pk_mul_f32 v[46:47], v[146:147], v[150:151]
    v_pk_mul_f32 v[48:49], v[152:153], v[156:157]
    v_pk_mul_f32 v[50:51], v[154:155], v[158:159]
    v_exp_f32 v36, v36
    v_exp_f32 v37, v37
    v_exp_f32 v38, v38
    v_exp_f32 v39, v39
    v_exp_f32 v40, v40
    v_exp_f32 v41, v41
    v_exp_f32 v42, v42
    v_exp_f32 v43, v43
    v_pk_fma_f32 v[36:37], v[36:37], v[62:63], v[62:63] op_sel_hi:[1,0,0]
    v_pk_fma_f32 v[38:39], v[38:39], v[62:63], v[62:63] op_sel_hi:[1,0,0]
    v_pk_fma_f32 v[40:41], v[40:41], v[62:63], v[62:63] op_sel_hi:[1,0,0]
    v_pk_fma_f32 v[42:43], v[42:43], v[62:63], v[62:63] op_sel_hi:[1,0,0]
    v_rcp_f32 v36, v36
    v_rcp_f32 v37, v37
    v_rcp_f32 v38, v38
    v_rcp_f32 v39, v39
    v_rcp_f32 v40, v40
    v_rcp_f32 v41, v41
    v_rcp_f32 v42, v42
    v_rcp_f32 v43, v43
    v_pk_mul_f32 v[36:37], v[36:37], v[44:45]
    v_pk_mul_f32 v[38:39], v[38:39], v[46:47]
    v_pk_mul_f32 v[40:41], v[40:41], v[48:49]
    v_pk_mul_f32 v[42:43], v[42:43], v[50:51]
    v_cvt_pk_bf16_f32 v56, v36, v37
    v_cvt_pk_bf16_f32 v57, v38, v39
    v_cvt_pk_bf16_f32 v58, v40, v41
    v_cvt_pk_bf16_f32 v59, v42, v43
    buffer_store_dwordx4 v[56:59], v163, s[8:11], s1 offen sc1
    s_waitcnt vmcnt(3)
    v_add_u32 v3, 2, v18
    s_mov_b64 exec, 1
    buffer_store_dword v3, v19, s[8:11], s40 offen
    buffer_store_dword v3, v19, s[8:11], s41 offen sc1
    s_mov_b64 exec, -1
    s_waitcnt vmcnt(4)
G1_done:
    s_mov_b32 s6, 0
H4_in1:
    v_subrev_u32 v3, s44, v17
    v_subrev_u32 v3, 1, v3
    v_cmp_lt_u32 vcc, 2, v3
    s_cbranch_vccz H4_ok1
    s_add_u32 s6, s6, 1
    s_cmp_gt_u32 s6, 1048576
    s_cbranch_scc1 H4_ok1
    global_load_dword v17, v16, s[42:43] sc1
    s_waitcnt vmcnt(0)
    s_branch H4_in1
H4_ok1:
    s_add_u32 m0, s37, 32768
    s_nop 0
    buffer_load_dwordx4 v163, s[8:11], s36 offen offset:0 sc1 lds
    buffer_load_dwordx4 v163, s[8:11], s36 offen offset:1024 sc1 lds
    buffer_load_dwordx4 v163, s[8:11], s36 offen offset:2048 sc1 lds
    buffer_load_dwordx4 v163, s[8:11], s36 offen offset:3072 sc1 lds
    s_add_u32 m0, s37, 49152
    s_add_u32 s36, s36, 8192
    buffer_load_dwordx4 v163, s[8:11], s36 offen offset:0 sc1 lds
    buffer_load_dwordx4 v163, s[8:11], s36 offen offset:1024 sc1 lds
    buffer_load_dwordx4 v163, s[8:11], s36 offen offset:2048 sc1 lds
    buffer_load_dwordx4 v163, s[8:11], s36 offen offset:3072 sc1 lds
    global_load_dword v17, v16, s[42:43] sc1
    s_add_u32 m0, s60, 0
    s_add_u32 s36, s36, 8192
    buffer_load_dwordx4 v163, s[8:11], s36 offen offset:0 sc1 lds
    buffer_load_dwordx4 v163, s[8:11], s36 offen offset:1024 sc1 lds
    buffer_load_dwordx4 v163, s[8:11], s36 offen offset:2048 sc1 lds
    buffer_load_dwordx4 v163, s[8:11], s36 offen offset:3072 sc1 lds
    s_waitcnt vmcnt(15)
    v_add_u32 v3, 3, v18
    s_mov_b64 exec, 1
    buffer_store_dword v3, v19, s[8:11], s40 offen
    buffer_store_dword v3, v19, s[8:11], s41 offen sc1
    s_mov_b64 exec, -1
    s_barrier
    ds_read_b64_tr_b16 a[120:121], v4 offset:8192
    ds_read_b64_tr_b16 a[122:123], v4 offset:9216
    ds_read_b64_tr_b16 a[124:125], v4 offset:10240
    ds_read_b64_tr_b16 a[126:127], v4 offset:11264
    ds_read_b64_tr_b16 a[128:129], v4 offset:12288
    ds_read_b64_tr_b16 a[130:131], v4 offset:13312
    ds_read_b64_tr_b16 a[132:133], v4 offset:14336
    ds_read_b64_tr_b16 a[134:135], v4 offset:15360
    ds_read_b64_tr_b16 a[136:137], v5 offset:8192
    ds_read_b64_tr_b16 a[138:139], v5 offset:9216
    ds_read_b64_tr_b16 a[140:141], v5 offset:10240
    ds_read_b64_tr_b16 a[142:143], v5 offset:11264
    ds_read_b64_tr_b16 a[144:145], v5 offset:12288
    ds_read_b64_tr_b16 a[146:147], v5 offset:13312
    ds_read_b64_tr_b16 a[148:149], v5 offset:14336
    ds_read_b64_tr_b16 a[150:151], v5 offset:15360
    ds_read_b64_tr_b16 a[152:153], v4 offset:16384
    ds_read_b64_tr_b16 a[154:155], v4 offset:17408
    ds_read_b64_tr_b16 a[156:157], v4 offset:18432
    ds_read_b64_tr_b16 a[158:159], v4 offset:19456
    ds_read_b64_tr_b16 a[160:161], v4 offset:20480
    ds_read_b64_tr_b16 a[162:163], v4 offset:21504
    ds_read_b64_tr_b16 a[164:165], v4 offset:22528
    ds_read_b64_tr_b16 a[166:167], v4 offset:23552
    ds_read_b64_tr_b16 a[168:169], v5 offset:16384
    ds_read_b64_tr_b16 a[170:171], v5 offset:17408
    ds_read_b64_tr_b16 a[172:173], v5 offset:18432
    ds_read_b64_tr_b16 a[174:175], v5 offset:19456
    ds_read_b64_tr_b16 a[176:177], v5 offset:20480
    ds_read_b64_tr_b16 a[178:179], v5 offset:21504
    ds_read_b64_tr_b16 a[180:181], v5 offset:22528
    ds_read_b64_tr_b16 a[182:183], v5 offset:23552
    s_lshl_b32 s4, s50, 13
    s_mul_i32 s5, s50, 49152
    s_add_u32 s5, s5, 65536
    v_add_u32 v8, s4, v163
    v_add_u32 v9, s5, v163
    s_waitcnt vmcnt(11) lgkmcnt(0)
    s_barrier
    ds_read_b128 v[64:67], v8 offset:32768
    ds_read_b128 v[68:71], v8 offset:33792
    ds_read_b128 v[72:75], v8 offset:34816
    ds_read_b128 v[76:79], v8 offset:35840
    ds_read_b128 v[80:83], v8 offset:36864
    s_waitcnt lgkmcnt(3)
    v_mfma_f32_32x32x16_bf16 v[32:47], a[0:3], v[64:67], 0
    ds_read_b64_tr_b16 a[184:185], v4 offset:24576
    ds_read_b64_tr_b16 a[186:187], v4 offset:25600
    ds_read_b128 v[84:87], v8 offset:37888
    v_mfma_f32_32x32x16_bf16 v[32:47], a[4:7], v[68:71], v[32:47]
    ds_read_b64_tr_b16 a[188:189], v4 offset:26624
    ds_read_b64_tr_b16 a[190:191], v4 offset:27648
    s_waitcnt vmcnt(6)
    v_subrev_u32 v3, s44, v17
    v_subrev_u32 v3, 2, v3
    v_cmp_lt_u32 vcc, 1, v3
    s_cbranch_vccnz H4_slow2
H4_ok2:
    s_add_u32 m0, s60, 8192
    s_add_u32 s36, s36, 8192
    buffer_load_dwordx4 v163, s[8:11], s36 offen offset:0 sc1 lds
    ds_read_b128 v[88:91], v8 offset:38912
    s_waitcnt lgkmcnt(7)
    v_mfma_f32_32x32x16_bf16 v[32:47], a[8:11], v[72:75], v[32:47]
    ds_read_b64_tr_b16 a[192:193], v4 offset:28672
    ds_read_b64_tr_b16 a[194:195], v4 offset:29696
    buffer_load_dwordx4 v163, s[8:11], s36 offen offset:1024 sc1 lds
    ds_read_b128 v[92:95], v8 offset:39936
    v_mfma_f32_32x32x16_bf16 v[32:47], a[12:15], v[76:79], v[32:47]
    ds_read_b64_tr_b16 a[196:197], v4 offset:30720
    ds_read_b64_tr_b16 a[198:199], v4 offset:31744
    buffer_load_dwordx4 v163, s[8:11], s36 offen offset:2048 sc1 lds
    s_waitcnt vmcnt(10)
    s_barrier
    ds_read_b128 v[96:99], v8 offset:49152
    s_waitcnt lgkmcnt(9)
    v_mfma_f32_32x32x16_bf16 v[32:47], a[16:19], v[80:83], v[32:47]
    ds_read_b64_tr_b16 a[200:201], v5 offset:24576
    ds_read_b64_tr_b16 a[202:203], v5 offset:25600
    buffer_load_dwordx4 v163, s[8:11], s36 offen offset:3072 sc1 lds
    ds_read_b128 v[100:103], v8 offset:50176
    v_mfma_f32_32x32x16_bf16 v[32:47], a[20:23], v[84:87], v[32:47]
    ds_read_b64_tr_b16 a[204:205], v5 offset:26624
    ds_read_b64_tr_b16 a[206:207], v5 offset:27648
    s_add_u32 m0, s60, 16384
    s_add_u32 s36, s36, 8192
    buffer_load_dwordx4 v163, s[8:11], s36 offen offset:0 sc1 lds
    ds_read_b128 v[104:107], v8 offset:51200
    s_waitcnt lgkmcnt(9)
    v_mfma_f32_32x32x16_bf16 v[32:47], a[24:27], v[88:91], v[32:47]
    ds_read_b64_tr_b16 a[208:209], v5 offset:28672
    ds_read_b64_tr_b16 a[210:211], v5 offset:29696
PG10:
    s_cbranch_execz WARM2_0_ret
    ds_read_b128 v[108:111], v8 offset:52224
    v_mfma_f32_32x32x16_bf16 v[32:47], a[28:31], v[92:95], v[32:47]
    ds_read_b64_tr_b16 a[212:213], v5 offset:30720
    ds_read_b64_tr_b16 a[214:215], v5 offset:31744
    buffer_load_dwordx4 v163, s[8:11], s36 offen offset:1024 sc1 lds
    ds_read_b128 v[112:115], v8 offset:53248
    s_waitcnt lgkmcnt(9)
    v_mfma_f32_32x32x16_bf16 v[32:47], a[32:35], v[96:99], v[32:47]
    ds_read_b64_tr_b16 a[216:217], v4 offset:32768
    ds_read_b64_tr_b16 a[218:219], v4 offset:33792
    ds_read_b128 v[116:119], v8 offset:54272
    v_mfma_f32_32x32x16_bf16 v[32:47], a[36:39], v[100:103], v[32:47]
    ds_read_b64_tr_b16 a[220:221], v4 offset:34816
    ds_read_b64_tr_b16 a[222:223], v4 offset:35840
    buffer_load_dwordx4 v163, s[8:11], s36 offen offset:2048 sc1 lds
    ds_read_b128 v[120:123], v8 offset:55296
    s_waitcnt lgkmcnt(9)
    v_mfma_f32_32x32x16_bf16 v[32:47], a[40:43], v[104:107], v[32:47]
    ds_read_b64_tr_b16 a[224:225], v4 offset:36864
    ds_read_b64_tr_b16 a[226:227], v4 offset:37888
    ds_read_b128 v[124:127], v8 offset:56320
    v_mfma_f32_32x32x16_bf16 v[32:47], a[44:47], v[108:111], v[32:47]
    ds_read_b64_tr_b16 a[228:229], v4 offset:38912
    ds_read_b64_tr_b16 a[230:231], v4 offset:39936
    buffer_load_dwordx4 v163, s[8:11], s36 offen offset:3072 sc1 lds
    s_waitcnt lgkmcnt(11)
    s_waitcnt vmcnt(10)
    s_barrier
    ds_read_b128 v[64:67], v9 offset:0
    v_mfma_f32_32x32x16_bf16 v[32:47], a[48:51], v[112:115], v[32:47]
    ds_read_b64_tr_b16 a[232:233], v5 offset:32768
    ds_read_b64_tr_b16 a[234:235], v5 offset:33792
    global_load_dword v17, v16, s[42:43] sc1
    ds_read_b128 v[68:71], v9 offset:1024
    s_waitcnt lgkmcnt(9)
    v_mfma_f32_32x32x16_bf16 v[32:47], a[52:55], v[116:119], v[32:47]
    ds_read_b64_tr_b16 a[236:237], v5 offset:34816
    ds_read_b64_tr_b16 a[238:239], v5 offset:35840
    s_add_u32 m0, s60, 24576
    s_add_u32 s36, s36, 8192
    buffer_load_dwordx4 v163, s[8:11], s36 offen offset:0 sc1 lds
    ds_read_b128 v[72:75], v9 offset:2048
    v_mfma_f32_32x32x16_bf16 v[32:47], a[56:59], v[120:123], v[32:47]
    ds_read_b64_tr_b16 a[240:241], v5 offset:36864
    ds_read_b64_tr_b16 a[242:243], v5 offset:37888
    ds_read_b128 v[76:79], v9 offset:3072
    s_waitcnt lgkmcnt(9)
    v_mfma_f32_32x32x16_bf16 v[32:47], a[60:63], v[124:127], v[32:47]
    ds_read_b64_tr_b16 a[244:245], v5 offset:38912
    ds_read_b64_tr_b16 a[246:247], v5 offset:39936
    buffer_load_dwordx4 v163, s[8:11], s36 offen offset:1024 sc1 lds
    ds_read_b128 v[80:83], v9 offset:4096
    v_mfma_f32_32x32x16_bf16 v[32:47], a[64:67], v[64:67], v[32:47]
    ds_read_b64_tr_b16 a[248:249], v165 offset:0
    ds_read_b64_tr_b16 a[250:251], v165 offset:1024
    ds_read_b128 v[84:87], v9 offset:5120
    s_waitcnt lgkmcnt(9)
    v_mfma_f32_32x32x16_bf16 v[32:47], a[68:71], v[68:71], v[32:47]
    ds_read_b64_tr_b16 a[252:253], v165 offset:2048
    ds_read_b64_tr_b16 a[254:255], v165 offset:3072
    buffer_load_dwordx4 v163, s[8:11], s36 offen offset:2048 sc1 lds
    ds_read_b128 v[88:91], v9 offset:6144
    v_mfma_f32_32x32x16_bf16 v[32:47], a[72:75], v[72:75], v[32:47]
    ds_read_b64_tr_b16 v[168:169], v165 offset:4096
    ds_read_b64_tr_b16 v[170:171], v165 offset:5120
    ds_read_b128 v[92:95], v9 offset:7168
    s_waitcnt lgkmcnt(9)
    v_mfma_f32_32x32x16_bf16 v[32:47], a[76:79], v[76:79], v[32:47]
    ds_read_b64_tr_b16 v[172:173], v165 offset:6144
    ds_read_b64_tr_b16 v[174:175], v165 offset:7168
    buffer_load_dwordx4 v163, s[8:11], s36 offen offset:3072 sc1 lds
    s_waitcnt vmcnt(9)
    s_barrier
    ds_read_b128 v[96:99], v9 offset:8192
    v_mfma_f32_32x32x16_bf16 v[32:47], a[80:83], v[80:83], v[32:47]
    ds_read_b64_tr_b16 v[176:177], v165 offset:8192
    ds_read_b64_tr_b16 v[178:179], v165 offset:9216
    ds_read_b128 v[100:103], v9 offset:9216
    s_waitcnt lgkmcnt(9)
    v_mfma_f32_32x32x16_bf16 v[32:47], a[84:87], v[84:87], v[32:47]
    ds_read_b64_tr_b16 v[180:181], v165 offset:10240
    ds_read_b64_tr_b16 v[182:183], v165 offset:11264
    s_add_u32 m0, s60, 32768
    s_add_u32 s36, s36, 8192
    buffer_load_dwordx4 v163, s[8:11], s36 offen offset:0 sc1 lds
    ds_read_b128 v[104:107], v9 offset:10240
    v_mfma_f32_32x32x16_bf16 v[32:47], a[88:91], v[88:91], v[32:47]
    ds_read_b64_tr_b16 v[184:185], v165 offset:12288
    ds_read_b64_tr_b16 v[186:187], v165 offset:13312
    ds_read_b128 v[108:111], v9 offset:11264
    s_waitcnt lgkmcnt(9)
    v_mfma_f32_32x32x16_bf16 v[32:47], a[92:95], v[92:95], v[32:47]
    ds_read_b64_tr_b16 v[188:189], v165 offset:14336
    ds_read_b64_tr_b16 v[190:191], v165 offset:15360
    buffer_load_dwordx4 v163, s[8:11], s36 offen offset:1024 sc1 lds
    ds_read_b128 v[112:115], v9 offset:12288
    v_mfma_f32_32x32x16_bf16 v[32:47], a[96:99], v[96:99], v[32:47]
    ds_read_b64_tr_b16 v[192:193], v165 offset:16384
    ds_read_b64_tr_b16 v[194:195], v165 offset:17408
    ds_read_b128 v[116:119], v9 offset:13312
    s_waitcnt lgkmcnt(9)
    v_mfma_f32_32x32x16_bf16 v[32:47], a[100:103], v[100:103], v[32:47]
    ds_read_b64_tr_b16 v[196:197], v165 offset:18432
    ds_read_b64_tr_b16 v[198:199], v165 offset:19456
    buffer_load_dwordx4 v163, s[8:11], s36 offen offset:2048 sc1 lds
    ds_read_b128 v[120:123], v9 offset:14336
    v_mfma_f32_32x32x16_bf16 v[32:47], a[104:107], v[104:107], v[32:47]
    ds_read_b64_tr_b16 v[200:201], v165 offset:20480
    ds_read_b64_tr_b16 v[202:203], v165 offset:21504
    ds_read_b128 v[124:127], v9 offset:15360
    s_waitcnt lgkmcnt(9)
    v_mfma_f32_32x32x16_bf16 v[32:47], a[108:111], v[108:111], v[32:47]
    ds_read_b64_tr_b16 v[204:205], v165 offset:22528
    ds_read_b64_tr_b16 v[206:207], v165 offset:23552
    buffer_load_dwordx4 v163, s[8:11], s36 offen offset:3072 sc1 lds
    s_waitcnt vmcnt(9)
    s_barrier
    ds_read_b128 v[64:67], v9 offset:16384
    v_mfma_f32_32x32x16_bf16 v[32:47], a[112:115], v[112:115], v[32:47]
    ds_read_b64_tr_b16 v[208:209], v165 offset:24576
    ds_read_b64_tr_b16 v[210:211], v165 offset:25600
    s_waitcnt vmcnt(8)
    v_subrev_u32 v3, s44, v17
    v_subrev_u32 v3, 3, v3
    v_cmp_lt_u32 vcc, 0, v3
    s_cbranch_vccnz H4_slow3
H4_ok3:
    ds_read_b128 v[68:71], v9 offset:17408
    s_waitcnt lgkmcnt(9)
    v_mfma_f32_32x32x16_bf16 v[32:47], a[116:119], v[116:119], v[32:47]
    ds_read_b64_tr_b16 v[212:213], v165 offset:26624
    ds_read_b64_tr_b16 v[214:215], v165 offset:27648
    s_add_u32 m0, s37, 0
    s_add_u32 s36, s36, 8192
    buffer_load_dwordx4 v163, s[8:11], s36 offen offset:0 sc1 lds
    ds_read_b128 v[72:75], v9 offset:18432
    v_mfma_f32_32x32x16_bf16 v[32:47], a[120:123], v[120:123], v[32:47]
    ds_read_b64_tr_b16 v[216:217], v165 offset:28672
    ds_read_b64_tr_b16 v[218:219], v165 offset:29696
    ds_read_b128 v[76:79], v9 offset:19456
    s_waitcnt lgkmcnt(9)
    v_mfma_f32_32x32x16_bf16 v[32:47], a[124:127], v[124:127], v[32:47]
    ds_read_b64_tr_b16 v[220:221], v165 offset:30720
    ds_read_b64_tr_b16 v[222:223], v165 offset:31744
    buffer_load_dwordx4 v163, s[8:11], s36 offen offset:1024 sc1 lds
    ds_read_b128 v[80:83], v9 offset:20480
    v_mfma_f32_32x32x16_bf16 v[32:47], a[128:131], v[64:67], v[32:47]
    ds_read_b64_tr_b16 v[224:225], v4 offset:40960
    ds_read_b64_tr_b16 v[226:227], v4 offset:41984
    ds_read_b128 v[84:87], v9 offset:21504
    s_waitcnt lgkmcnt(9)
    v_mfma_f32_32x32x16_bf16 v[32:47], a[132:135], v[68:71], v[32:47]
    ds_read_b64_tr_b16 v[228:229], v4 offset:43008
    ds_read_b64_tr_b16 v[230:231], v4 offset:44032
    buffer_load_dwordx4 v163, s[8:11], s36 offen offset:2048 sc1 lds
    ds_read_b128 v[88:91], v9 offset:22528
    v_mfma_f32_32x32x16_bf16 v[32:47], a[136:139], v[72:75], v[32:47]
    ds_read_b64_tr_b16 v[232:233], v4 offset:45056
    ds_read_b64_tr_b16 v[234:235], v4 offset:46080
    ds_read_b128 v[92:95], v9 offset:23552
    s_waitcnt lgkmcnt(9)
    v_mfma_f32_32x32x16_bf16 v[32:47], a[140:143], v[76:79], v[32:47]
    ds_read_b64_tr_b16 v[236:237], v4 offset:47104
    ds_read_b64_tr_b16 v[238:239], v4 offset:48128
    buffer_load_dwordx4 v163, s[8:11], s36 offen offset:3072 sc1 lds
    s_waitcnt vmcnt(8)
    s_barrier
    ds_read_b128 v[96:99], v9 offset:24576
    v_mfma_f32_32x32x16_bf16 v[32:47], a[144:147], v[80:83], v[32:47]
    ds_read_b64_tr_b16 v[240:241], v5 offset:40960
    ds_read_b64_tr_b16 v[242:243], v5 offset:41984
    ds_read_b128 v[100:103], v9 offset:25600
    s_waitcnt lgkmcnt(9)
    v_mfma_f32_32x32x16_bf16 v[32:47], a[148:151], v[84:87], v[32:47]
    ds_read_b64_tr_b16 v[244:245], v5 offset:43008
    ds_read_b64_tr_b16 v[246:247], v5 offset:44032
    s_add_u32 m0, s37, 16384
    s_add_u32 s36, s36, 8192
    buffer_load_dwordx4 v163, s[8:11], s36 offen offset:0 sc1 lds
    ds_read_b128 v[104:107], v9 offset:26624
    v_mfma_f32_32x32x16_bf16 v[32:47], a[152:155], v[88:91], v[32:47]
    ds_read_b64_tr_b16 v[248:249], v5 offset:45056
    ds_read_b64_tr_b16 v[250:251], v5 offset:46080
    ds_read_b128 v[108:111], v9 offset:27648
    s_waitcnt lgkmcnt(9)
    v_mfma_f32_32x32x16_bf16 v[32:47], a[156:159], v[92:95], v[32:47]
    ds_read_b64_tr_b16 v[252:253], v5 offset:47104
    ds_read_b64_tr_b16 v[254:255], v5 offset:48128
    buffer_load_dwordx4 v163, s[8:11], s36 offen offset:1024 sc1 lds
    v_and_b32 v2, 31, v1
    v_lshlrev_b32 v10, 1, v7
    ds_read_b128 v[112:115], v9 offset:28672
    v_mfma_f32_32x32x16_bf16 v[32:47], a[160:163], v[96:99], v[32:47]
    v_xor_b32 v11, s47, v10
    v_lshlrev_b32 v11, 6, v11
    ds_read_b128 v[116:119], v9 offset:29696
    s_waitcnt lgkmcnt(7)
    v_mfma_f32_32x32x16_bf16 v[32:47], a[164:167], v[100:103], v[32:47]
    buffer_load_dwordx4 v163, s[8:11], s36 offen offset:2048 sc1 lds
    v_lshl_add_u32 v11, v7, 9, v11
    v_lshl_add_u32 v11, v2, 1, v11
    ds_read_b128 v[120:123], v9 offset:30720
    v_mfma_f32_32x32x16_bf16 v[32:47], a[168:171], v[104:107], v[32:47]
    v_xor_b32 v12, 0x140, v11
    s_lshl_b32 s12, s53, 17
    s_lshl_b32 s5, s56, 13
    s_add_u32 s12, s12, s5
    ds_read_b128 v[124:127], v9 offset:31744
    s_waitcnt lgkmcnt(3)
    v_mfma_f32_32x32x16_bf16 v[32:47], a[172:175], v[108:111], v[32:47]
    buffer_load_dwordx4 v163, s[8:11], s36 offen offset:3072 sc1 lds
    s_lshl_b32 s5, s49, 12
    s_add_u32 s12, s12, s5
    s_add_u32 s12, s12, 6291456
    s_add_u32 s13, s12, 0x10000
    s_waitcnt vmcnt(8)
    s_barrier
    ds_read_b128 v[64:67], v9 offset:32768
    v_mfma_f32_32x32x16_bf16 v[32:47], a[176:179], v[112:115], v[32:47]
    v_lshlrev_b32 v2, 10, v2
    v_lshl_add_u32 v2, v7, 4, v2
    ds_read_b128 v[68:71], v9 offset:33792
    s_waitcnt lgkmcnt(3)
    v_mfma_f32_32x32x16_bf16 v[32:47], a[180:183], v[116:119], v[32:47]
    s_add_u32 m0, s60, 40960
    s_add_u32 s36, s36, 8192
    buffer_load_dwordx4 v163, s[8:11], s36 offen offset:0 sc1 lds
    s_lshl_b32 s4, s53, 17
    s_lshl_b32 s5, s47, 15
    s_add_u32 s4, s4, s5
    s_lshl_b32 s5, s56, 7
    s_add_u32 s4, s4, s5
    ds_read_b128 v[72:75], v9 offset:34816
    v_mfma_f32_32x32x16_bf16 v[32:47], a[184:187], v[120:123], v[32:47]
    s_lshl_b32 s5, s49, 6
    s_add_u32 s4, s4, s5
    v_add_u32 v6, s4, v2
    ds_read_b128 v[76:79], v9 offset:35840
    s_waitcnt lgkmcnt(3)
    v_mfma_f32_32x32x16_bf16 v[32:47], a[188:191], v[124:127], v[32:47]
    buffer_load_dwordx4 v163, s[8:11], s36 offen offset:1024 sc1 lds
    v_mov_b32 v140, 0
    v_mov_b32 v141, 0
    ds_read_b128 v[80:83], v9 offset:36864
    v_mfma_f32_32x32x16_bf16 v[32:47], a[192:195], v[64:67], v[32:47]
    v_mov_b32 v142, 0
    v_mov_b32 v143, 0
    ds_read_b128 v[84:87], v9 offset:37888
    s_waitcnt lgkmcnt(3)
    v_mfma_f32_32x32x16_bf16 v[32:47], a[196:199], v[68:71], v[32:47]
    buffer_load_dwordx4 v163, s[8:11], s36 offen offset:2048 sc1 lds
    v_mov_b32 v144, 0
    v_mov_b32 v145, 0
    ds_read_b128 v[88:91], v9 offset:38912
    v_mfma_f32_32x32x16_bf16 v[32:47], a[200:203], v[72:75], v[32:47]
    v_mov_b32 v146, 0
    v_mov_b32 v147, 0
    ds_read_b128 v[92:95], v9 offset:39936
    s_waitcnt lgkmcnt(3)
    v_mfma_f32_32x32x16_bf16 v[32:47], a[204:207], v[76:79], v[32:47]
    buffer_load_dwordx4 v163, s[8:11], s36 offen offset:3072 sc1 lds
    v_mov_b32 v148, 0
    v_mov_b32 v149, 0
    s_waitcnt vmcnt(8)
    s_barrier
    ds_read_b128 v[96:99], v8 offset:0
    v_mfma_f32_32x32x16_bf16 v[32:47], a[208:211], v[80:83], v[32:47]
    v_mov_b32 v150, 0
    v_mov_b32 v151, 0
    ds_read_b128 v[100:103], v8 offset:1024
    s_waitcnt lgkmcnt(3)
    v_mfma_f32_32x32x16_bf16 v[32:47], a[212:215], v[84:87], v[32:47]
    s_mov_b32 m0, s51
    s_nop 0
    buffer_load_dwordx4 v163, s[8:11], s48 offen offset:0 sc1 lds
    v_mov_b32 v152, 0
    v_mov_b32 v153, 0
    ds_read_b128 v[104:107], v8 offset:2048
    v_mfma_f32_32x32x16_bf16 v[32:47], a[216:219], v[88:91], v[32:47]
    v_mov_b32 v154, 0
    v_mov_b32 v155, 0
    ds_read_b128 v[108:111], v8 offset:3072
    s_waitcnt lgkmcnt(3)
    v_mfma_f32_32x32x16_bf16 v[32:47], a[220:223], v[92:95], v[32:47]
    buffer_load_dwordx4 v163, s[8:11], s48 offen offset:1024 sc1 lds
    v_and_b32 v2, 31, v1
    v_lshl_add_u32 v2, s50, 5, v2
    ds_read_b128 v[112:115], v8 offset:4096
    v_mfma_f32_32x32x16_bf16 v[32:47], a[224:227], v[96:99], v[32:47]
    v_lshl_add_u32 v20, s49, 2, v7
    v_and_b32 v13, 7, v1
    ds_read_b128 v[116:119], v8 offset:5120
    s_waitcnt lgkmcnt(3)
    v_mfma_f32_32x32x16_bf16 v[32:47], a[228:231], v[100:103], v[32:47]
    buffer_load_dwordx4 v163, s[8:11], s48 offen offset:2048 sc1 lds
    v_xor_b32 v20, v20, v13
    v_lshlrev_b32 v20, 4, v20
    ds_read_b128 v[120:123], v8 offset:6144
    v_mfma_f32_32x32x16_bf16 v[32:47], a[232:235], v[104:107], v[32:47]
    v_lshl_add_u32 v13, v2, 7, v20
    v_xor_b32 v14, 32, v13
    ds_read_b128 v[124:127], v8 offset:7168
    s_waitcnt lgkmcnt(3)
    v_mfma_f32_32x32x16_bf16 v[32:47], a[236:239], v[108:111], v[32:47]
    v_lshrrev_b32 v2, 3, v1
    v_and_b32 v20, 7, v1
    s_waitcnt vmcnt(7)
    s_barrier
    ds_read_b128 v[64:67], v8 offset:16384
    v_mfma_f32_32x32x16_bf16 v[32:47], a[240:243], v[112:115], v[32:47]
    buffer_load_short_d16_hi v140, v11, s[8:11], s12 offen offset:0 sc1
    v_xor_b32 v15, v2, v20
    v_lshlrev_b32 v15, 4, v15
    ds_read_b128 v[68:71], v8 offset:17408
    s_waitcnt lgkmcnt(3)
    v_mfma_f32_32x32x16_bf16 v[32:47], a[244:247], v[116:119], v[32:47]
    buffer_load_short_d16_hi v141, v11, s[8:11], s13 offen offset:0 sc1
    v_lshl_add_u32 v15, v2, 7, v15
    v_add_u32 v15, s57, v15
    ds_read_b128 v[72:75], v8 offset:18432
    v_mfma_f32_32x32x16_bf16 v[32:47], a[248:251], v[120:123], v[32:47]
    buffer_load_short_d16_hi v142, v12, s[8:11], s12 offen offset:0 sc1
    s_lshl_b32 s4, s53, 17
    s_lshl_b32 s5, s55, 16
    ds_read_b128 v[76:79], v8 offset:19456
    s_waitcnt lgkmcnt(3)
    v_mfma_f32_32x32x16_bf16 v[32:47], a[252:255], v[124:127], v[32:47]
    buffer_load_short_d16_hi v143, v12, s[8:11], s13 offen offset:0 sc1
    s_add_u32 s4, s4, s5
    s_lshl_b32 s5, s3, 14
    ds_read_b128 v[80:83], v8 offset:20480
    v_mfma_f32_32x32x16_bf16 v[32:47], v[168:171], v[64:67], v[32:47]
    buffer_load_short_d16_hi v144, v11, s[8:11], s12 offen offset:1024 sc1
    s_add_u32 s4, s4, s5
    s_lshl_b32 s5, s56, 7
    ds_read_b128 v[84:87], v8 offset:21504
    s_waitcnt lgkmcnt(3)
    v_mfma_f32_32x32x16_bf16 v[32:47], v[172:175], v[68:71], v[32:47]
    buffer_load_short_d16_hi v145, v11, s[8:11], s13 offen offset:1024 sc1
    s_add_u32 s4, s4, s5
    v_lshlrev_b32 v20, 4, v20
    ds_read_b128 v[88:91], v8 offset:22528
    v_mfma_f32_32x32x16_bf16 v[32:47], v[176:179], v[72:75], v[32:47]
    buffer_load_short_d16_hi v146, v12, s[8:11], s12 offen offset:1024 sc1
    v_lshl_add_u32 v2, v2, 10, v20
    v_add_u32 v18, s4, v2
    ds_read_b128 v[92:95], v8 offset:23552
    s_waitcnt lgkmcnt(3)
    v_mfma_f32_32x32x16_bf16 v[32:47], v[180:183], v[76:79], v[32:47]
    buffer_load_short_d16_hi v147, v12, s[8:11], s13 offen offset:1024 sc1
    v_add_u32 v19, 0x2000, v18
    s_waitcnt vmcnt(11)
    s_barrier
    ds_read_b128 v[96:99], v9 offset:40960
    v_mfma_f32_32x32x16_bf16 v[32:47], v[184:187], v[80:83], v[32:47]
    buffer_load_short_d16_hi v148, v11, s[8:11], s12 offen offset:2048 sc1
    ds_read_b128 v[100:103], v9 offset:41984
    s_waitcnt lgkmcnt(3)
    v_mfma_f32_32x32x16_bf16 v[32:47], v[188:191], v[84:87], v[32:47]
    buffer_load_short_d16_hi v149, v11, s[8:11], s13 offen offset:2048 sc1
    ds_read_b128 v[104:107], v9 offset:43008
    v_mfma_f32_32x32x16_bf16 v[32:47], v[192:195], v[88:91], v[32:47]
    buffer_load_short_d16_hi v150, v12, s[8:11], s12 offen offset:2048 sc1
    ds_read_b128 v[108:111], v9 offset:44032
    s_waitcnt lgkmcnt(3)
    v_mfma_f32_32x32x16_bf16 v[32:47], v[196:199], v[92:95], v[32:47]
    buffer_load_short_d16_hi v151, v12, s[8:11], s13 offen offset:2048 sc1
    ds_read_b128 v[112:115], v9 offset:45056
    v_mfma_f32_32x32x16_bf16 v[32:47], v[200:203], v[96:99], v[32:47]
    buffer_load_short_d16_hi v152, v11, s[8:11], s12 offen offset:3072 sc1
    ds_read_b128 v[116:119], v9 offset:46080
    s_waitcnt lgkmcnt(3)
    v_mfma_f32_32x32x16_bf16 v[32:47], v[204:207], v[100:103], v[32:47]
    buffer_load_short_d16_hi v153, v11, s[8:11], s13 offen offset:3072 sc1
    ds_read_b128 v[120:123], v9 offset:47104
    v_mfma_f32_32x32x16_bf16 v[32:47], v[208:211], v[104:107], v[32:47]
    buffer_load_short_d16_hi v154, v12, s[8:11], s12 offen offset:3072 sc1
    ds_read_b128 v[124:127], v9 offset:48128
    s_waitcnt lgkmcnt(3)
    v_mfma_f32_32x32x16_bf16 v[32:47], v[212:215], v[108:111], v[32:47]
    buffer_load_short_d16_hi v155, v12, s[8:11], s13 offen offset:3072 sc1
    s_waitcnt vmcnt(16)
    s_barrier
    ds_read_b128 v[64:67], v8 offset:32768
    v_mfma_f32_32x32x16_bf16 v[32:47], v[216:219], v[112:115], v[32:47]
    ds_read_b128 v[68:71], v8 offset:33792
    s_waitcnt lgkmcnt(3)
    v_mfma_f32_32x32x16_bf16 v[32:47], v[220:223], v[116:119], v[32:47]
    ds_read_b128 v[72:75], v8 offset:34816
    v_mfma_f32_32x32x16_bf16 v[32:47], v[224:227], v[120:123], v[32:47]
    ds_read_b128 v[76:79], v8 offset:35840
    s_waitcnt lgkmcnt(3)
    v_mfma_f32_32x32x16_bf16 v[32:47], v[228:231], v[124:127], v[32:47]
    ds_read_b128 v[80:83], v8 offset:36864
    v_mfma_f32_32x32x16_bf16 v[32:47], v[232:235], v[64:67], v[32:47]
    ds_read_b128 v[84:87], v8 offset:37888
    s_waitcnt lgkmcnt(3)
    v_mfma_f32_32x32x16_bf16 v[32:47], v[236:239], v[68:71], v[32:47]
    v_mfma_f32_32x32x16_bf16 v[32:47], v[240:243], v[72:75], v[32:47]
    s_waitcnt lgkmcnt(1)
    v_mfma_f32_32x32x16_bf16 v[32:47], v[244:247], v[76:79], v[32:47]
    v_mfma_f32_32x32x16_bf16 v[32:47], v[248:251], v[80:83], v[32:47]
    s_waitcnt lgkmcnt(0)
    v_mfma_f32_32x32x16_bf16 v[32:47], v[252:255], v[84:87], v[32:47]
    s_mov_b32 s4, 0x3f80
    s_mov_b32 s5, 0x3f800000
    s_waitcnt vmcnt(0)
    s_nop 8
    v_cvt_pk_bf16_f32 v48, v32, v33
    v_cvt_pk_bf16_f32 v49, v34, v35
    v_cvt_pk_bf16_f32 v50, v36, v37
    v_cvt_pk_bf16_f32 v51, v38, v39
    v_cvt_pk_bf16_f32 v52, v40, v41
    v_cvt_pk_bf16_f32 v53, v42, v43
    v_cvt_pk_bf16_f32 v54, v44, v45
    v_cvt_pk_bf16_f32 v55, v46, v47
    v_dot2_f32_bf16 v32, v48, s4, v140
    v_dot2_f32_bf16 v33, v48, s5, v141
    v_dot2_f32_bf16 v34, v49, s4, v142
    v_dot2_f32_bf16 v35, v49, s5, v143
    v_dot2_f32_bf16 v36, v50, s4, v144
    v_dot2_f32_bf16 v37, v50, s5, v145
    v_dot2_f32_bf16 v38, v51, s4, v146
    v_dot2_f32_bf16 v39, v51, s5, v147
    v_dot2_f32_bf16 v40, v52, s4, v148
    v_dot2_f32_bf16 v41, v52, s5, v149
    v_dot2_f32_bf16 v42, v53, s4, v150
    v_dot2_f32_bf16 v43, v53, s5, v151
    v_dot2_f32_bf16 v44, v54, s4, v152
    v_dot2_f32_bf16 v45, v54, s5, v153
    v_dot2_f32_bf16 v46, v55, s4, v154
    v_dot2_f32_bf16 v47, v55, s5, v155
    v_cvt_pk_bf16_f32 v48, v32, v33
    v_cvt_pk_bf16_f32 v49, v34, v35
    v_cvt_pk_bf16_f32 v50, v36, v37
    v_cvt_pk_bf16_f32 v51, v38, v39
    v_cvt_pk_bf16_f32 v52, v40, v41
    v_cvt_pk_bf16_f32 v53, v42, v43
    v_cvt_pk_bf16_f32 v54, v44, v45
    v_cvt_pk_bf16_f32 v55, v46, v47
    v_permlane32_swap_b32 v48, v50
    v_permlane32_swap_b32 v49, v51
    ds_write_b128 v13, v[48:51]
    v_permlane32_swap_b32 v52, v54
    v_permlane32_swap_b32 v53, v55
    ds_write_b128 v14, v[52:55]
    s_waitcnt lgkmcnt(0)
    s_barrier
    ds_read_b128 v[48:51], v15
    ds_read_b128 v[52:55], v15 offset:1024
    s_waitcnt lgkmcnt(1)
    global_store_dwordx4 v18, v[48:51], s[38:39] nt
    s_waitcnt lgkmcnt(0)
    global_store_dwordx4 v19, v[52:55], s[38:39] nt
K_end:
    s_endpgm
H2_slow:
    s_mov_b32 s6, 0
    global_load_dword v18, v15, s[42:43] sc1
    s_waitcnt vmcnt(0)
H2_spoll:
    v_cmpx_ne_u32 vcc, s44, v18
    s_cbranch_execz H2_spoll_done
    s_add_u32 s6, s6, 1
    s_cmp_gt_u32 s6, 1048576
    s_cbranch_scc1 H2_spoll_done
    global_load_dword v18, v15, s[42:43] sc1
    s_waitcnt vmcnt(0)
    s_branch H2_spoll
H2_spoll_done:
    s_mov_b64 exec, -1
    s_branch H2_ok
G1_slow:
    s_mov_b32 s6, 0
    buffer_load_dwordx4 v[196:199], v163, s[8:11], s0 offen sc1
    buffer_load_dwordx4 v[200:203], v8, s[8:11], s46 offen offset:0 sc1
    buffer_load_dwordx4 v[204:207], v8, s[8:11], s46 offen offset:512 sc1
    s_waitcnt vmcnt(0)
G1_poll:
    v_xor_b32 v2, s44, v199
    v_bitop3_b32 v2, v203, s44, v2 bitop3:0xbe
    v_bitop3_b32 v2, v207, s44, v2 bitop3:0xbe
    v_cmpx_ne_u32 vcc, 0, v2
    s_cbranch_execz G1_poll_done
    s_add_u32 s6, s6, 1
    s_cmp_gt_u32 s6, 1048576
    s_cbranch_scc1 G1_poll_done
    buffer_load_dwordx4 v[196:199], v163, s[8:11], s0 offen sc1
    buffer_load_dwordx4 v[200:203], v8, s[8:11], s46 offen offset:0 sc1
    buffer_load_dwordx4 v[204:207], v8, s[8:11], s46 offen offset:512 sc1
    s_waitcnt vmcnt(0)
    s_branch G1_poll
G1_poll_done:
    s_mov_b64 exec, -1
    v_mov_b32 v208, v196
    v_mov_b32 v212, v197
    v_mov_b32 v216, v198
    v_perm_b32 v228, v202, v202, v220
    v_and_b32 v60, 0xffff0000, v202
    v_perm_b32 v232, v206, v206, v220
    v_and_b32 v62, 0xffff0000, v206
    v_mul_f32 v60, v60, v60
    v_mul_f32 v62, v62, v62
    s_branch G1_tagok
H4_slow2:
    s_mov_b32 s6, 0
    global_load_dword v17, v16, s[42:43] sc1
    s_waitcnt vmcnt(0)
H4_poll2:
    v_subrev_u32 v3, s44, v17
    v_subrev_u32 v3, 2, v3
    v_cmpx_lt_u32 vcc, 1, v3
    s_cbranch_execz H4_poll2_done
    s_add_u32 s6, s6, 1
    s_cmp_gt_u32 s6, 1048576
    s_cbranch_scc1 H4_poll2_done
    global_load_dword v17, v16, s[42:43] sc1
    s_waitcnt vmcnt(0)
    s_branch H4_poll2
H4_poll2_done:
    s_mov_b64 exec, -1
    s_branch H4_ok2
H4_slow3:
    s_mov_b32 s6, 0
    global_load_dword v17, v16, s[42:43] sc1
    s_waitcnt vmcnt(0)
H4_poll3:
    v_subrev_u32 v3, s44, v17
    v_subrev_u32 v3, 3, v3
    v_cmpx_lt_u32 vcc, 0, v3
    s_cbranch_execz H4_poll3_done
    s_add_u32 s6, s6, 1
    s_cmp_gt_u32 s6, 1048576
    s_cbranch_scc1 H4_poll3_done
    global_load_dword v17, v16, s[42:43] sc1
    s_waitcnt vmcnt(0)
    s_branch H4_poll3
H4_poll3_done:
    s_mov_b64 exec, -1
    s_branch H4_ok3
G1_stats:
PG11:
    s_cbranch_execz WARM2_0_ret
    s_add_u32 s5, s59, 0
    s_add_u32 m0, s57, 0
    s_nop 0
    buffer_load_dwordx4 v163, s[8:11], s5 offen sc1 lds
    buffer_load_dwordx4 v163, s[8:11], s5 offen offset:1024 sc1 lds
    s_add_u32 s5, s59, 8192
    s_add_u32 m0, s57, 8192
    s_nop 0
    buffer_load_dwordx4 v163, s[8:11], s5 offen sc1 lds
    buffer_load_dwordx4 v163, s[8:11], s5 offen offset:1024 sc1 lds
    s_add_u32 s5, s59, 16384
    s_add_u32 m0, s57, 16384
    s_nop 0
    buffer_load_dwordx4 v163, s[8:11], s5 offen sc1 lds
    buffer_load_dwordx4 v163, s[8:11], s5 offen offset:1024 sc1 lds
    s_add_u32 s5, s59, 24576
    s_add_u32 m0, s57, 24576
    s_nop 0
    buffer_load_dwordx4 v163, s[8:11], s5 offen sc1 lds
    buffer_load_dwordx4 v163, s[8:11], s5 offen offset:1024 sc1 lds
    s_waitcnt lgkmcnt(0)
    s_barrier
    s_add_u32 s5, s59, 32768
    s_add_u32 m0, s57, 65536
    s_nop 0
    buffer_load_dwordx4 v163, s[8:11], s5 offen sc1 lds
    buffer_load_dwordx4 v163, s[8:11], s5 offen offset:1024 sc1 lds
    s_add_u32 s5, s59, 40960
    s_add_u32 m0, s57, 73728
    s_nop 0
    buffer_load_dwordx4 v163, s[8:11], s5 offen sc1 lds
    buffer_load_dwordx4 v163, s[8:11], s5 offen offset:1024 sc1 lds
    s_add_u32 s5, s59, 49152
    s_add_u32 m0, s57, 81920
    s_nop 0
    buffer_load_dwordx4 v163, s[8:11], s5 offen sc1 lds
    buffer_load_dwordx4 v163, s[8:11], s5 offen offset:1024 sc1 lds
    s_add_u32 s5, s59, 57344
    s_add_u32 m0, s57, 90112
    s_nop 0
    buffer_load_dwordx4 v163, s[8:11], s5 offen sc1 lds
    buffer_load_dwordx4 v163, s[8:11], s5 offen offset:1024 sc1 lds
    s_mov_b32 s46, 0x3f803f80
    v_mov_b32 v60, 0
    v_mov_b32 v61, 0
    v_mov_b32 v62, 0
    v_mov_b32 v63, 0
    v_add_u32 v16, 0x40000, v16
    v_add_u32 v11, 0x10000, v10
    v_add_u32 v12, 0x20000, v10
    v_and_b32 v8, 31, v1
    v_lshlrev_b32 v8, 4, v8
    v_lshl_add_u32 v9, v7, 13, v8
    s_lshl_b32 s0, s53, 14
    s_lshl_b32 s5, s49, 9
    s_add_u32 s0, s0, s5
    s_add_u32 s0, s0, 262144
    s_add_u32 s1, s0, 4096
    s_waitcnt vmcnt(8)
    s_barrier
    global_load_dword v17, v16, s[42:43] sc1
    ds_read_b64_tr_b16 v[20:21], v10 offset:0
    ds_read_b64_tr_b16 v[22:23], v10 offset:1024
    ds_read_b64_tr_b16 v[24:25], v10 offset:4096
    ds_read_b64_tr_b16 v[26:27], v10 offset:5120
    ds_read_b64_tr_b16 v[28:29], v10 offset:8192
    ds_read_b64_tr_b16 v[30:31], v10 offset:9216
    ds_read_b64_tr_b16 v[32:33], v10 offset:12288
    ds_read_b64_tr_b16 v[34:35], v10 offset:13312
    ds_read_b64_tr_b16 v[36:37], v10 offset:16384
    ds_read_b64_tr_b16 v[38:39], v10 offset:17408
    ds_read_b64_tr_b16 v[40:41], v10 offset:20480
    ds_read_b64_tr_b16 v[42:43], v10 offset:21504
    ds_read_b64_tr_b16 v[44:45], v10 offset:24576
    ds_read_b64_tr_b16 v[46:47], v10 offset:25600
    ds_read_b64_tr_b16 v[48:49], v10 offset:28672
    ds_read_b64_tr_b16 v[50:51], v10 offset:29696
    s_waitcnt lgkmcnt(12)
    v_dot2_f32_bf16 v60, v20, s46, v60
    v_dot2_f32_bf16 v62, v20, v20, v62
    v_dot2_f32_bf16 v61, v21, s46, v61
    v_dot2_f32_bf16 v63, v21, v21, v63
    v_dot2_f32_bf16 v60, v22, s46, v60
    v_dot2_f32_bf16 v62, v22, v22, v62
    v_dot2_f32_bf16 v61, v23, s46, v61
    v_dot2_f32_bf16 v63, v23, v23, v63
    v_dot2_f32_bf16 v60, v24, s46, v60
    v_dot2_f32_bf16 v62, v24, v24, v62
    v_dot2_f32_bf16 v61, v25, s46, v61
    v_dot2_f32_bf16 v63, v25, v25, v63
    v_dot2_f32_bf16 v60, v26, s46, v60
    v_dot2_f32_bf16 v62, v26, v26, v62
    v_dot2_f32_bf16 v61, v27, s46, v61
    v_dot2_f32_bf16 v63, v27, v27, v63
    s_waitcnt lgkmcnt(8)
    v_dot2_f32_bf16 v60, v28, s46, v60
    v_dot2_f32_bf16 v62, v28, v28, v62
    v_dot2_f32_bf16 v61, v29, s46, v61
    v_dot2_f32_bf16 v63, v29, v29, v63
    v_dot2_f32_bf16 v60, v30, s46, v60
    v_dot2_f32_bf16 v62, v30, v30, v62
    v_dot2_f32_bf16 v61, v31, s46, v61
    v_dot2_f32_bf16 v63, v31, v31, v63
    v_dot2_f32_bf16 v60, v32, s46, v60
    v_dot2_f32_bf16 v62, v32, v32, v62
    v_dot2_f32_bf16 v61, v33, s46, v61
    v_dot2_f32_bf16 v63, v33, v33, v63
    v_dot2_f32_bf16 v60, v34, s46, v60
    v_dot2_f32_bf16 v62, v34, v34, v62
    v_dot2_f32_bf16 v61, v35, s46, v61
    v_dot2_f32_bf16 v63, v35, v35, v63
    s_waitcnt lgkmcnt(4)
    v_dot2_f32_bf16 v60, v36, s46, v60
    v_dot2_f32_bf16 v62, v36, v36, v62
    v_dot2_f32_bf16 v61, v37, s46, v61
    v_dot2_f32_bf16 v63, v37, v37, v63
    v_dot2_f32_bf16 v60, v38, s46, v60
    v_dot2_f32_bf16 v62, v38, v38, v62
    v_dot2_f32_bf16 v61, v39, s46, v61
    v_dot2_f32_bf16 v63, v39, v39, v63
    v_dot2_f32_bf16 v60, v40, s46, v60
    v_dot2_f32_bf16 v62, v40, v40, v62
    v_dot2_f32_bf16 v61, v41, s46, v61
    v_dot2_f32_bf16 v63, v41, v41, v63
    v_dot2_f32_bf16 v60, v42, s46, v60
    v_dot2_f32_bf16 v62, v42, v42, v62
    v_dot2_f32_bf16 v61, v43, s46, v61
    v_dot2_f32_bf16 v63, v43, v43, v63
    s_waitcnt lgkmcnt(0)
    v_dot2_f32_bf16 v60, v44, s46, v60
    v_dot2_f32_bf16 v62, v44, v44, v62
    v_dot2_f32_bf16 v61, v45, s46, v61
    v_dot2_f32_bf16 v63, v45, v45, v63
    v_dot2_f32_bf16 v60, v46, s46, v60
    v_dot2_f32_bf16 v62, v46, v46, v62
    v_dot2_f32_bf16 v61, v47, s46, v61
    v_dot2_f32_bf16 v63, v47, v47, v63
    v_dot2_f32_bf16 v60, v48, s46, v60
    v_dot2_f32_bf16 v62, v48, v48, v62
    v_dot2_f32_bf16 v61, v49, s46, v61
    v_dot2_f32_bf16 v63, v49, v49, v63
    v_dot2_f32_bf16 v60, v50, s46, v60
    v_dot2_f32_bf16 v62, v50, v50, v62
    v_dot2_f32_bf16 v61, v51, s46, v61
    v_dot2_f32_bf16 v63, v51, v51, v63
    s_mov_b32 s6, 0
    s_waitcnt vmcnt(0)
H2_tpoll:
    v_subrev_u32 v17, s44, v17
    v_cmpx_lt_u32 vcc, 15, v17
    s_cbranch_execz H2_tpoll_done
    s_add_u32 s6, s6, 1
    s_cmp_gt_u32 s6, 1048576
    s_cbranch_scc1 H2_tpoll_done
    global_load_dword v17, v16, s[42:43] sc1
    s_waitcnt vmcnt(0)
    s_branch H2_tpoll
H2_tpoll_done:
    s_mov_b64 exec, -1
    v_mov_b32 v3, s44
    s_mov_b64 exec, 1
    buffer_store_dword v3, v15, s[8:11], s40 offen
    buffer_store_dword v3, v15, s[8:11], s41 offen sc1
    s_mov_b64 exec, -1
    s_add_u32 s5, s59, 65536
    s_add_u32 m0, s57, 98304
    s_nop 0
    buffer_load_dwordx4 v163, s[8:11], s5 offen sc1 lds
    buffer_load_dwordx4 v163, s[8:11], s5 offen offset:1024 sc1 lds
    s_add_u32 s5, s59, 73728
    s_add_u32 m0, s57, 106496
    s_nop 0
    buffer_load_dwordx4 v163, s[8:11], s5 offen sc1 lds
    buffer_load_dwordx4 v163, s[8:11], s5 offen offset:1024 sc1 lds
    s_add_u32 s5, s59, 81920
    s_add_u32 m0, s57, 114688
    s_nop 0
    buffer_load_dwordx4 v163, s[8:11], s5 offen sc1 lds
    buffer_load_dwordx4 v163, s[8:11], s5 offen offset:1024 sc1 lds
    s_add_u32 s5, s59, 90112
    s_add_u32 m0, s57, 122880
    s_nop 0
    buffer_load_dwordx4 v163, s[8:11], s5 offen sc1 lds
    buffer_load_dwordx4 v163, s[8:11], s5 offen offset:1024 sc1 lds
    s_add_u32 s5, s59, 98304
    s_add_u32 m0, s57, 131072
    s_nop 0
    buffer_load_dwordx4 v163, s[8:11], s5 offen sc1 lds
    buffer_load_dwordx4 v163, s[8:11], s5 offen offset:1024 sc1 lds
    s_add_u32 s5, s59, 106496
    s_add_u32 m0, s57, 139264
    s_nop 0
    buffer_load_dwordx4 v163, s[8:11], s5 offen sc1 lds
    buffer_load_dwordx4 v163, s[8:11], s5 offen offset:1024 sc1 lds
    s_add_u32 s5, s59, 114688
    s_add_u32 m0, s57, 147456
    s_nop 0
    buffer_load_dwordx4 v163, s[8:11], s5 offen sc1 lds
    buffer_load_dwordx4 v163, s[8:11], s5 offen offset:1024 sc1 lds
    s_add_u32 s5, s59, 122880
    s_add_u32 m0, s57, 155648
    s_nop 0
    buffer_load_dwordx4 v163, s[8:11], s5 offen sc1 lds
    buffer_load_dwordx4 v163, s[8:11], s5 offen offset:1024 sc1 lds
    s_barrier
    ds_read_b64_tr_b16 v[20:21], v11 offset:0
    ds_read_b64_tr_b16 v[22:23], v11 offset:1024
    ds_read_b64_tr_b16 v[24:25], v11 offset:4096
    ds_read_b64_tr_b16 v[26:27], v11 offset:5120
    ds_read_b64_tr_b16 v[28:29], v11 offset:8192
    ds_read_b64_tr_b16 v[30:31], v11 offset:9216
    ds_read_b64_tr_b16 v[32:33], v11 offset:12288
    ds_read_b64_tr_b16 v[34:35], v11 offset:13312
    ds_read_b64_tr_b16 v[36:37], v11 offset:16384
    ds_read_b64_tr_b16 v[38:39], v11 offset:17408
    ds_read_b64_tr_b16 v[40:41], v11 offset:20480
    ds_read_b64_tr_b16 v[42:43], v11 offset:21504
    ds_read_b64_tr_b16 v[44:45], v11 offset:24576
    ds_read_b64_tr_b16 v[46:47], v11 offset:25600
    ds_read_b64_tr_b16 v[48:49], v11 offset:28672
    ds_read_b64_tr_b16 v[50:51], v11 offset:29696
    s_waitcnt lgkmcnt(12)
    v_dot2_f32_bf16 v60, v20, s46, v60
    v_dot2_f32_bf16 v62, v20, v20, v62
    v_dot2_f32_bf16 v61, v21, s46, v61
    v_dot2_f32_bf16 v63, v21, v21, v63
    buffer_load_dwordx4 v[64:67], v9, s[8:11], s0 offen offset:0 sc1
    v_dot2_f32_bf16 v60, v22, s46, v60
    v_dot2_f32_bf16 v62, v22, v22, v62
    v_dot2_f32_bf16 v61, v23, s46, v61
    v_dot2_f32_bf16 v63, v23, v23, v63
    buffer_load_dwordx4 v[68:71], v9, s[8:11], s0 offen offset:1024 sc1
    v_dot2_f32_bf16 v60, v24, s46, v60
    v_dot2_f32_bf16 v62, v24, v24, v62
    v_dot2_f32_bf16 v61, v25, s46, v61
    v_dot2_f32_bf16 v63, v25, v25, v63
    buffer_load_dwordx4 v[72:75], v9, s[8:11], s0 offen offset:2048 sc1
    v_dot2_f32_bf16 v60, v26, s46, v60
    v_dot2_f32_bf16 v62, v26, v26, v62
    v_dot2_f32_bf16 v61, v27, s46, v61
    v_dot2_f32_bf16 v63, v27, v27, v63
    buffer_load_dwordx4 v[76:79], v9, s[8:11], s0 offen offset:3072 sc1
    s_waitcnt lgkmcnt(8)
    v_dot2_f32_bf16 v60, v28, s46, v60
    v_dot2_f32_bf16 v62, v28, v28, v62
    v_dot2_f32_bf16 v61, v29, s46, v61
    v_dot2_f32_bf16 v63, v29, v29, v63
    buffer_load_dwordx4 v[80:83], v9, s[8:11], s1 offen offset:0 sc1
    v_dot2_f32_bf16 v60, v30, s46, v60
    v_dot2_f32_bf16 v62, v30, v30, v62
    v_dot2_f32_bf16 v61, v31, s46, v61
    v_dot2_f32_bf16 v63, v31, v31, v63
    buffer_load_dwordx4 v[84:87], v9, s[8:11], s1 offen offset:1024 sc1
    v_dot2_f32_bf16 v60, v32, s46, v60
    v_dot2_f32_bf16 v62, v32, v32, v62
    v_dot2_f32_bf16 v61, v33, s46, v61
    v_dot2_f32_bf16 v63, v33, v33, v63
    buffer_load_dwordx4 v[88:91], v9, s[8:11], s1 offen offset:2048 sc1
    v_dot2_f32_bf16 v60, v34, s46, v60
    v_dot2_f32_bf16 v62, v34, v34, v62
    v_dot2_f32_bf16 v61, v35, s46, v61
    v_dot2_f32_bf16 v63, v35, v35, v63
    buffer_load_dwordx4 v[92:95], v9, s[8:11], s1 offen offset:3072 sc1
    s_waitcnt lgkmcnt(4)
    v_dot2_f32_bf16 v60, v36, s46, v60
    v_dot2_f32_bf16 v62, v36, v36, v62
    v_dot2_f32_bf16 v61, v37, s46, v61
    v_dot2_f32_bf16 v63, v37, v37, v63
    v_dot2_f32_bf16 v60, v38, s46, v60
    v_dot2_f32_bf16 v62, v38, v38, v62
    v_dot2_f32_bf16 v61, v39, s46, v61
    v_dot2_f32_bf16 v63, v39, v39, v63
    v_dot2_f32_bf16 v60, v40, s46, v60
    v_dot2_f32_bf16 v62, v40, v40, v62
    v_dot2_f32_bf16 v61, v41, s46, v61
    v_dot2_f32_bf16 v63, v41, v41, v63
    v_dot2_f32_bf16 v60, v42, s46, v60
    v_dot2_f32_bf16 v62, v42, v42, v62
    v_dot2_f32_bf16 v61, v43, s46, v61
    v_dot2_f32_bf16 v63, v43, v43, v63
    s_waitcnt lgkmcnt(0)
    v_dot2_f32_bf16 v60, v44, s46, v60
    v_dot2_f32_bf16 v62, v44, v44, v62
    v_dot2_f32_bf16 v61, v45, s46, v61
    v_dot2_f32_bf16 v63, v45, v45, v63
    v_dot2_f32_bf16 v60, v46, s46, v60
    v_dot2_f32_bf16 v62, v46, v46, v62
    v_dot2_f32_bf16 v61, v47, s46, v61
    v_dot2_f32_bf16 v63, v47, v47, v63
    v_dot2_f32_bf16 v60, v48, s46, v60
    v_dot2_f32_bf16 v62, v48, v48, v62
    v_dot2_f32_bf16 v61, v49, s46, v61
    v_dot2_f32_bf16 v63, v49, v49, v63
    v_dot2_f32_bf16 v60, v50, s46, v60
    v_dot2_f32_bf16 v62, v50, v50, v62
    v_dot2_f32_bf16 v61, v51, s46, v61
    v_dot2_f32_bf16 v63, v51, v51, v63
    s_waitcnt vmcnt(16)
    s_barrier
    ds_read_b64_tr_b16 v[20:21], v11 offset:32768
    ds_read_b64_tr_b16 v[22:23], v11 offset:33792
    ds_read_b64_tr_b16 v[24:25], v11 offset:36864
    ds_read_b64_tr_b16 v[26:27], v11 offset:37888
    ds_read_b64_tr_b16 v[28:29], v11 offset:40960
    ds_read_b64_tr_b16 v[30:31], v11 offset:41984
    ds_read_b64_tr_b16 v[32:33], v11 offset:45056
    ds_read_b64_tr_b16 v[34:35], v11 offset:46080
    ds_read_b64_tr_b16 v[36:37], v11 offset:49152
    ds_read_b64_tr_b16 v[38:39], v11 offset:50176
    ds_read_b64_tr_b16 v[40:41], v11 offset:53248
    ds_read_b64_tr_b16 v[42:43], v11 offset:54272
    ds_read_b64_tr_b16 v[44:45], v11 offset:57344
    ds_read_b64_tr_b16 v[46:47], v11 offset:58368
    ds_read_b64_tr_b16 v[48:49], v11 offset:61440
    ds_read_b64_tr_b16 v[50:51], v11 offset:62464
    s_waitcnt lgkmcnt(12)
    v_dot2_f32_bf16 v60, v20, s46, v60
    v_dot2_f32_bf16 v62, v20, v20, v62
    v_dot2_f32_bf16 v61, v21, s46, v61
    v_dot2_f32_bf16 v63, v21, v21, v63
    v_dot2_f32_bf16 v60, v22, s46, v60
    v_dot2_f32_bf16 v62, v22, v22, v62
    v_dot2_f32_bf16 v61, v23, s46, v61
    v_dot2_f32_bf16 v63, v23, v23, v63
    v_dot2_f32_bf16 v60, v24, s46, v60
    v_dot2_f32_bf16 v62, v24, v24, v62
    v_dot2_f32_bf16 v61, v25, s46, v61
    v_dot2_f32_bf16 v63, v25, v25, v63
    v_dot2_f32_bf16 v60, v26, s46, v60
    v_dot2_f32_bf16 v62, v26, v26, v62
    v_dot2_f32_bf16 v61, v27, s46, v61
    v_dot2_f32_bf16 v63, v27, v27, v63
    s_waitcnt lgkmcnt(8)
    v_dot2_f32_bf16 v60, v28, s46, v60
    v_dot2_f32_bf16 v62, v28, v28, v62
    v_dot2_f32_bf16 v61, v29, s46, v61
    v_dot2_f32_bf16 v63, v29, v29, v63
    v_dot2_f32_bf16 v60, v30, s46, v60
    v_dot2_f32_bf16 v62, v30, v30, v62
    v_dot2_f32_bf16 v61, v31, s46, v61
    v_dot2_f32_bf16 v63, v31, v31, v63
    v_dot2_f32_bf16 v60, v32, s46, v60
    v_dot2_f32_bf16 v62, v32, v32, v62
    v_dot2_f32_bf16 v61, v33, s46, v61
    v_dot2_f32_bf16 v63, v33, v33, v63
    v_dot2_f32_bf16 v60, v34, s46, v60
    v_dot2_f32_bf16 v62, v34, v34, v62
    v_dot2_f32_bf16 v61, v35, s46, v61
    v_dot2_f32_bf16 v63, v35, v35, v63
    s_waitcnt lgkmcnt(4)
    v_dot2_f32_bf16 v60, v36, s46, v60
    v_dot2_f32_bf16 v62, v36, v36, v62
    v_dot2_f32_bf16 v61, v37, s46, v61
    v_dot2_f32_bf16 v63, v37, v37, v63
    v_dot2_f32_bf16 v60, v38, s46, v60
    v_dot2_f32_bf16 v62, v38, v38, v62
    v_dot2_f32_bf16 v61, v39, s46, v61
    v_dot2_f32_bf16 v63, v39, v39, v63
    v_dot2_f32_bf16 v60, v40, s46, v60
    v_dot2_f32_bf16 v62, v40, v40, v62
    v_dot2_f32_bf16 v61, v41, s46, v61
    v_dot2_f32_bf16 v63, v41, v41, v63
    v_dot2_f32_bf16 v60, v42, s46, v60
    v_dot2_f32_bf16 v62, v42, v42, v62
    v_dot2_f32_bf16 v61, v43, s46, v61
    v_dot2_f32_bf16 v63, v43, v43, v63
    s_waitcnt lgkmcnt(0)
    v_dot2_f32_bf16 v60, v44, s46, v60
    v_dot2_f32_bf16 v62, v44, v44, v62
    v_dot2_f32_bf16 v61, v45, s46, v61
    v_dot2_f32_bf16 v63, v45, v45, v63
    v_dot2_f32_bf16 v60, v46, s46, v60
    v_dot2_f32_bf16 v62, v46, v46, v62
    v_dot2_f32_bf16 v61, v47, s46, v61
    v_dot2_f32_bf16 v63, v47, v47, v63
    v_dot2_f32_bf16 v60, v48, s46, v60
    v_dot2_f32_bf16 v62, v48, v48, v62
    v_dot2_f32_bf16 v61, v49, s46, v61
    v_dot2_f32_bf16 v63, v49, v49, v63
    v_dot2_f32_bf16 v60, v50, s46, v60
    v_dot2_f32_bf16 v62, v50, v50, v62
    v_dot2_f32_bf16 v61, v51, s46, v61
    v_dot2_f32_bf16 v63, v51, v51, v63
    s_waitcnt vmcnt(8)
    s_barrier
    ds_read_b64_tr_b16 v[20:21], v12 offset:0
    ds_read_b64_tr_b16 v[22:23], v12 offset:1024
    ds_read_b64_tr_b16 v[24:25], v12 offset:4096
    ds_read_b64_tr_b16 v[26:27], v12 offset:5120
    ds_read_b64_tr_b16 v[28:29], v12 offset:8192
    ds_read_b64_tr_b16 v[30:31], v12 offset:9216
    ds_read_b64_tr_b16 v[32:33], v12 offset:12288
    ds_read_b64_tr_b16 v[34:35], v12 offset:13312
    ds_read_b64_tr_b16 v[36:37], v12 offset:16384
    ds_read_b64_tr_b16 v[38:39], v12 offset:17408
    ds_read_b64_tr_b16 v[40:41], v12 offset:20480
    ds_read_b64_tr_b16 v[42:43], v12 offset:21504
    ds_read_b64_tr_b16 v[44:45], v12 offset:24576
    ds_read_b64_tr_b16 v[46:47], v12 offset:25600
    ds_read_b64_tr_b16 v[48:49], v12 offset:28672
    ds_read_b64_tr_b16 v[50:51], v12 offset:29696
    s_waitcnt lgkmcnt(12)
    v_dot2_f32_bf16 v60, v20, s46, v60
    v_dot2_f32_bf16 v62, v20, v20, v62
    v_dot2_f32_bf16 v61, v21, s46, v61
    v_dot2_f32_bf16 v63, v21, v21, v63
    v_dot2_f32_bf16 v60, v22, s46, v60
    v_dot2_f32_bf16 v62, v22, v22, v62
    v_dot2_f32_bf16 v61, v23, s46, v61
    v_dot2_f32_bf16 v63, v23, v23, v63
    v_dot2_f32_bf16 v60, v24, s46, v60
    v_dot2_f32_bf16 v62, v24, v24, v62
    v_dot2_f32_bf16 v61, v25, s46, v61
    v_dot2_f32_bf16 v63, v25, v25, v63
    v_dot2_f32_bf16 v60, v26, s46, v60
    v_dot2_f32_bf16 v62, v26, v26, v62
    v_dot2_f32_bf16 v61, v27, s46, v61
    v_dot2_f32_bf16 v63, v27, v27, v63
    s_waitcnt lgkmcnt(8)
    v_dot2_f32_bf16 v60, v28, s46, v60
    v_dot2_f32_bf16 v62, v28, v28, v62
    v_dot2_f32_bf16 v61, v29, s46, v61
    v_dot2_f32_bf16 v63, v29, v29, v63
    v_dot2_f32_bf16 v60, v30, s46, v60
    v_dot2_f32_bf16 v62, v30, v30, v62
    v_dot2_f32_bf16 v61, v31, s46, v61
    v_dot2_f32_bf16 v63, v31, v31, v63
    v_dot2_f32_bf16 v60, v32, s46, v60
    v_dot2_f32_bf16 v62, v32, v32, v62
    v_dot2_f32_bf16 v61, v33, s46, v61
    v_dot2_f32_bf16 v63, v33, v33, v63
    v_dot2_f32_bf16 v60, v34, s46, v60
    v_dot2_f32_bf16 v62, v34, v34, v62
    v_dot2_f32_bf16 v61, v35, s46, v61
    v_dot2_f32_bf16 v63, v35, v35, v63
    s_waitcnt lgkmcnt(4)
    v_dot2_f32_bf16 v60, v36, s46, v60
    v_dot2_f32_bf16 v62, v36, v36, v62
    v_dot2_f32_bf16 v61, v37, s46, v61
    v_dot2_f32_bf16 v63, v37, v37, v63
    v_dot2_f32_bf16 v60, v38, s46, v60
    v_dot2_f32_bf16 v62, v38, v38, v62
    v_dot2_f32_bf16 v61, v39, s46, v61
    v_dot2_f32_bf16 v63, v39, v39, v63
    v_dot2_f32_bf16 v60, v40, s46, v60
    v_dot2_f32_bf16 v62, v40, v40, v62
    v_dot2_f32_bf16 v61, v41, s46, v61
    v_dot2_f32_bf16 v63, v41, v41, v63
    v_dot2_f32_bf16 v60, v42, s46, v60
    v_dot2_f32_bf16 v62, v42, v42, v62
    v_dot2_f32_bf16 v61, v43, s46, v61
    v_dot2_f32_bf16 v63, v43, v43, v63
    s_waitcnt lgkmcnt(0)
    v_dot2_f32_bf16 v60, v44, s46, v60
    v_dot2_f32_bf16 v62, v44, v44, v62
    v_dot2_f32_bf16 v61, v45, s46, v61
    v_dot2_f32_bf16 v63, v45, v45, v63
    v_dot2_f32_bf16 v60, v46, s46, v60
    v_dot2_f32_bf16 v62, v46, v46, v62
    v_dot2_f32_bf16 v61, v47, s46, v61
    v_dot2_f32_bf16 v63, v47, v47, v63
    v_dot2_f32_bf16 v60, v48, s46, v60
    v_dot2_f32_bf16 v62, v48, v48, v62
    v_dot2_f32_bf16 v61, v49, s46, v61
    v_dot2_f32_bf16 v63, v49, v49, v63
    v_dot2_f32_bf16 v60, v50, s46, v60
    v_dot2_f32_bf16 v62, v50, v50, v62
    v_dot2_f32_bf16 v61, v51, s46, v61
    v_dot2_f32_bf16 v63, v51, v51, v63
    s_nop 1
    v_add_f32 v60, v60, v61
    v_add_f32 v62, v62, v63
    v_mov_b32 v61, v60
    v_mov_b32 v63, v62
    s_nop 0
    v_permlane32_swap_b32 v60, v61
    v_permlane32_swap_b32 v62, v63
    v_add_f32 v60, v60, v61
    v_add_f32 v62, v62, v63
    v_mul_f32 v60, 0x3b000000, v60
    v_mul_f32 v62, 0x3b000000, v62
    v_fma_f32 v62, -v60, v60, v62
    v_max_f32 v62, 0, v62
    v_cvt_pk_bf16_f32 v62, v62, v62
    v_and_b32 v62, 0xffff0000, v62
    v_add_f32 v62, 0x3727c5ac, v62
    v_cvt_pk_bf16_f32 v62, v62, v62
    v_and_b32 v62, 0xffff0000, v62
    v_sqrt_f32 v62, v62
    s_nop 0
    v_cvt_pk_bf16_f32 v22, -v60, v62
    v_and_b32 v62, 0xffff0000, v22
    v_rcp_f32 v62, v62
    s_nop 0
    v_mul_f32 v20, 0xc0135761, v62
    v_mul_f32 v21, v62, v62
    v_mul_f32 v21, v21, v62
    v_mul_f32 v21, 0xbdd2d3e8, v21
    v_mov_b32 v23, s44
    s_lshl_b32 s5, s53, 11
    s_lshl_b32 s6, s3, 9
    s_add_u32 s5, s5, s6
    s_add_u32 s5, s5, 65536
    s_mov_b32 exec_hi, 0
    buffer_store_dwordx4 v[20:23], v163, s[8:11], s5 offen sc1
    s_mov_b32 exec_hi, -1
    s_cmp_eq_u32 s53, 15
    s_cbranch_scc1 ST_nocs
    s_cmp_eq_u32 s50, 0
    s_cbranch_scc0 ST_nocs
    s_mov_b32 s6, 0
    s_waitcnt vmcnt(1)
ST_poll:
    v_xor_b32 v2, s44, v67
    v_bitop3_b32 v2, v71, s44, v2 bitop3:0xbe
    v_bitop3_b32 v2, v75, s44, v2 bitop3:0xbe
    v_bitop3_b32 v2, v79, s44, v2 bitop3:0xbe
    v_bitop3_b32 v2, v83, s44, v2 bitop3:0xbe
    v_bitop3_b32 v2, v87, s44, v2 bitop3:0xbe
    v_bitop3_b32 v2, v91, s44, v2 bitop3:0xbe
    v_bitop3_b32 v2, v95, s44, v2 bitop3:0xbe
    v_cmpx_ne_u32 vcc, 0, v2
    s_cbranch_execz ST_poll_done
    s_add_u32 s6, s6, 1
    s_cmp_gt_u32 s6, 1048576
    s_cbranch_scc1 ST_poll_done
    buffer_load_dwordx4 v[64:67], v9, s[8:11], s0 offen offset:0 sc1
    buffer_load_dwordx4 v[68:71], v9, s[8:11], s0 offen offset:1024 sc1
    buffer_load_dwordx4 v[72:75], v9, s[8:11], s0 offen offset:2048 sc1
    buffer_load_dwordx4 v[76:79], v9, s[8:11], s0 offen offset:3072 sc1
    buffer_load_dwordx4 v[80:83], v9, s[8:11], s1 offen offset:0 sc1
    buffer_load_dwordx4 v[84:87], v9, s[8:11], s1 offen offset:1024 sc1
    buffer_load_dwordx4 v[88:91], v9, s[8:11], s1 offen offset:2048 sc1
    buffer_load_dwordx4 v[92:95], v9, s[8:11], s1 offen offset:3072 sc1
    s_waitcnt vmcnt(0)
    s_branch ST_poll
ST_poll_done:
    s_mov_b64 exec, -1
    v_pk_add_f32 v[64:65], v[64:65], v[68:69]
    v_add_f32 v66, v66, v70
    v_pk_add_f32 v[72:73], v[72:73], v[76:77]
    v_add_f32 v74, v74, v78
    v_pk_add_f32 v[80:81], v[80:81], v[84:85]
    v_add_f32 v82, v82, v86
    v_pk_add_f32 v[88:89], v[88:89], v[92:93]
    v_add_f32 v90, v90, v94
    v_pk_add_f32 v[64:65], v[64:65], v[72:73]
    v_add_f32 v66, v66, v74
    v_pk_add_f32 v[80:81], v[80:81], v[88:89]
    v_add_f32 v82, v82, v90
    v_pk_add_f32 v[64:65], v[64:65], v[80:81]
    v_add_f32 v66, v66, v82
    v_cvt_pk_bf16_f32 v68, v64, v64
    v_and_b32 v68, 0xffff0000, v68
    v_sub_f32 v68, v64, v68
    v_cvt_pk_bf16_f32 v64, v64, v68
    v_cvt_pk_bf16_f32 v68, v65, v65
    v_and_b32 v68, 0xffff0000, v68
    v_sub_f32 v68, v65, v68
    v_cvt_pk_bf16_f32 v65, v65, v68
    v_cvt_pk_bf16_f32 v68, v66, v66
    v_and_b32 v68, 0xffff0000, v68
    v_sub_f32 v68, v66, v68
    v_cvt_pk_bf16_f32 v66, v66, v68
    s_lshl_b32 s4, s53, 11
    s_lshl_b32 s5, s49, 10
    s_add_u32 s4, s4, s5
    s_add_u32 s4, s4, 229376
    buffer_store_dwordx4 v[64:67], v163, s[8:11], s4 offen sc1
ST_nocs:
    s_add_u32 m0, s31, 32768
    s_add_u32 s30, s29, 0
    buffer_load_dwordx4 v164, s[16:19], s30 offen  lds
    s_add_u32 m0, s31, 36864
    s_add_u32 s30, s29, 98304
    buffer_load_dwordx4 v164, s[16:19], s30 offen  lds
    s_add_u32 m0, s31, 40960
    s_add_u32 s30, s29, 196608
    buffer_load_dwordx4 v164, s[16:19], s30 offen  lds
    s_add_u32 m0, s31, 45056
    s_add_u32 s30, s29, 589824
    buffer_load_dwordx4 v164, s[16:19], s30 offen  lds
    s_add_u32 m0, s31, 49152
    s_add_u32 s30, s29, 688128
    buffer_load_dwordx4 v164, s[16:19], s30 offen  lds
    s_add_u32 m0, s31, 53248
    s_add_u32 s30, s29, 786432
    buffer_load_dwordx4 v164, s[16:19], s30 offen  lds
    s_add_u32 m0, s31, 57344
    s_add_u32 s30, s29, 884736
    buffer_load_dwordx4 v164, s[16:19], s30 offen  lds
    s_add_u32 m0, s31, 61440
    s_add_u32 s30, s29, 983040
    buffer_load_dwordx4 v164, s[16:19], s30 offen  lds
    s_barrier
    s_add_u32 m0, s31, 65536
    s_add_u32 s30, s29, 1081344
    buffer_load_dwordx4 v164, s[16:19], s30 offen  lds
    s_add_u32 m0, s31, 114688
    s_add_u32 s30, s29, 1277952
    buffer_load_dwordx4 v164, s[16:19], s30 offen  lds
    s_add_u32 m0, s31, 69632
    s_add_u32 s30, s29, 1179648
    buffer_load_dwordx4 v164, s[16:19], s30 offen  lds
    s_add_u32 m0, s31, 73728
    s_add_u32 s30, s29, 65536
    buffer_load_dwordx4 v164, s[16:19], s30 offen  lds
    s_add_u32 m0, s31, 118784
    s_mov_b32 s30, 1376256
    s_cmp_eq_u32 s49, 0
    s_cselect_b32 s30, s30, 16384
    s_add_u32 s30, s30, s28
    buffer_load_dwordx4 v164, s[16:19], s30 offen  lds
    s_add_u32 m0, s31, 122880
    s_add_u32 s30, s29, 262144
    buffer_load_dwordx4 v164, s[16:19], s30 offen  lds
    s_add_u32 m0, s31, 77824
    s_add_u32 s30, s29, 163840
    buffer_load_dwordx4 v164, s[16:19], s30 offen  lds
    s_add_u32 m0, s31, 126976
    s_add_u32 s30, s29, 360448
    buffer_load_dwordx4 v164, s[16:19], s30 offen  lds
    s_add_u32 m0, s31, 81920
    s_add_u32 s30, s29, 458752
    buffer_load_dwordx4 v164, s[16:19], s30 offen  lds
    s_add_u32 m0, s31, 86016
    s_add_u32 s30, s29, 557056
    buffer_load_dwordx4 v164, s[16:19], s30 offen  lds
    s_add_u32 m0, s31, 131072
    s_add_u32 s30, s29, 655360
    buffer_load_dwordx4 v164, s[16:19], s30 offen  lds
    s_add_u32 m0, s31, 135168
    s_add_u32 s30, s29, 753664
    buffer_load_dwordx4 v164, s[16:19], s30 offen  lds
    s_add_u32 m0, s31, 90112
    s_add_u32 s30, s29, 851968
    buffer_load_dwordx4 v164, s[16:19], s30 offen  lds
    s_add_u32 m0, s31, 139264
    s_add_u32 s30, s29, 1048576
    buffer_load_dwordx4 v164, s[16:19], s30 offen  lds
    s_add_u32 m0, s31, 94208
    s_add_u32 s30, s29, 950272
    buffer_load_dwordx4 v164, s[16:19], s30 offen  lds
    s_add_u32 m0, s31, 98304
    s_add_u32 s30, s29, 1245184
    buffer_load_dwordx4 v164, s[16:19], s30 offen  lds
    s_add_u32 m0, s31, 143360
    s_add_u32 s30, s29, 1146880
    buffer_load_dwordx4 v164, s[16:19], s30 offen  lds
    s_add_u32 m0, s31, 147456
    s_add_u32 s30, s29, 32768
    buffer_load_dwordx4 v164, s[16:19], s30 offen  lds
    s_add_u32 m0, s31, 102400
    s_add_u32 s30, s29, 1343488
    buffer_load_dwordx4 v164, s[16:19], s30 offen  lds
    s_add_u32 m0, s31, 151552
    s_add_u32 s30, s29, 131072
    buffer_load_dwordx4 v164, s[16:19], s30 offen  lds
    s_add_u32 m0, s31, 106496
    s_add_u32 s30, s29, 1015808
    buffer_load_dwordx4 v164, s[16:19], s30 offen  lds
    s_add_u32 m0, s31, 110592
    s_add_u32 s30, s29, 1114112
    buffer_load_dwordx4 v164, s[16:19], s30 offen  lds
    s_add_u32 m0, s31, 155648
    s_add_u32 s30, s29, 1212416
    buffer_load_dwordx4 v164, s[16:19], s30 offen  lds
    s_add_u32 m0, s31, 159744
    s_add_u32 s30, s29, 1310720
    buffer_load_dwordx4 v164, s[16:19], s30 offen  lds
    s_add_u32 m0, s31, 0
    s_add_u32 s30, s29, 229376
    buffer_load_dwordx4 v164, s[16:19], s30 offen  lds
    s_add_u32 m0, s31, 4096
    s_add_u32 s30, s29, 327680
    buffer_load_dwordx4 v164, s[16:19], s30 offen  lds
    s_add_u32 m0, s31, 8192
    s_add_u32 s30, s29, 425984
    buffer_load_dwordx4 v164, s[16:19], s30 offen  lds
    s_add_u32 m0, s31, 12288
    s_add_u32 s30, s29, 524288
    buffer_load_dwordx4 v164, s[16:19], s30 offen  lds
    s_add_u32 m0, s31, 16384
    s_add_u32 s30, s29, 622592
    buffer_load_dwordx4 v164, s[16:19], s30 offen  lds
    s_add_u32 m0, s31, 20480
    s_add_u32 s30, s29, 720896
    buffer_load_dwordx4 v164, s[16:19], s30 offen  lds
    s_add_u32 m0, s31, 24576
    s_add_u32 s30, s29, 819200
    buffer_load_dwordx4 v164, s[16:19], s30 offen  lds
    s_add_u32 m0, s31, 28672
    s_add_u32 s30, s29, 917504
    buffer_load_dwordx4 v164, s[16:19], s30 offen  lds
    s_waitcnt vmcnt(32)
    s_barrier
    ds_read_b64_tr_b16 a[0:1], v165 offset:32768
    ds_read_b64_tr_b16 a[2:3], v165 offset:33792
    ds_read_b64_tr_b16 a[4:5], v165 offset:34816
    ds_read_b64_tr_b16 a[6:7], v165 offset:35840
    ds_read_b64_tr_b16 a[8:9], v165 offset:36864
    ds_read_b64_tr_b16 a[10:11], v165 offset:37888
    ds_read_b64_tr_b16 a[12:13], v165 offset:38912
    ds_read_b64_tr_b16 a[14:15], v165 offset:39936
    ds_read_b64_tr_b16 a[16:17], v165 offset:40960
    ds_read_b64_tr_b16 a[18:19], v165 offset:41984
    ds_read_b64_tr_b16 a[20:21], v165 offset:43008
    ds_read_b64_tr_b16 a[22:23], v165 offset:44032
    s_lshl_b32 s4, s53, 8
    s_add_u32 s4, s4, 196608
    s_lshl_b32 s7, s55, 7
    s_add_u32 s7, s7, s4
    v_min_u32 v16, 28, v1
    v_lshl_add_u32 v16, v16, 2, s7
    s_lshl_b32 s5, s54, 1
    s_add_u32 s61, s5, s49
    s_lshl_b32 s5, s50, 5
    s_add_u32 s5, s5, s61
    s_lshl_b32 s5, s5, 2
    s_add_u32 s5, s5, s4
    v_mov_b32 v19, s5
    s_lshl_b32 s4, s53, 2
    s_lshl_b32 s5, s50, 1
    s_add_u32 s5, s4, s5
    s_mul_i32 s5, s5, 88064
    s_lshl_b32 s52, s61, 10
    s_add_u32 s52, s52, s5
    s_add_u32 s52, s52, 8388608
    s_add_u32 s4, s4, s47
    s_mul_i32 s4, s4, 88064
    s_add_u32 s4, s4, 8388608
    s_lshl_b32 s37, s50, 13
    s_mul_i32 s5, s49, 3072
    s_add_u32 s48, s4, s5
    s_add_u32 s48, s48, 81920
    s_add_u32 s51, s37, s5
    s_add_u32 s51, s51, 32768
    s_lshl_b32 s5, s49, 12
    s_add_u32 s36, s4, s5
    s_add_u32 s37, s37, s5
    s_mul_i32 s60, s50, 49152
    s_add_u32 s60, s60, s5
    s_add_u32 s60, s60, 65536
    v_add_u32 v4, 65536, v165
    v_add_u32 v5, 114688, v165
    s_mov_b32 s40, 268435456
    s_mov_b32 s41, 268435456
    v_mov_b32 v18, s44
    s_waitcnt lgkmcnt(0)
    s_barrier
    s_add_u32 m0, s31, 32768
    s_add_u32 s30, s29, 294912
    buffer_load_dwordx4 v164, s[16:19], s30 offen  lds
    s_add_u32 m0, s31, 36864
    s_add_u32 s30, s29, 393216
    buffer_load_dwordx4 v164, s[16:19], s30 offen  lds
    s_add_u32 m0, s31, 40960
    s_add_u32 s30, s29, 491520
    buffer_load_dwordx4 v164, s[16:19], s30 offen  lds
    s_waitcnt vmcnt(0)
    s_barrier
    ds_read_b64_tr_b16 a[24:25], v165 offset:32768
    ds_read_b64_tr_b16 a[26:27], v165 offset:33792
    ds_read_b64_tr_b16 a[28:29], v165 offset:34816
    ds_read_b64_tr_b16 a[30:31], v165 offset:35840
    ds_read_b64_tr_b16 a[32:33], v165 offset:36864
    ds_read_b64_tr_b16 a[34:35], v165 offset:37888
    ds_read_b64_tr_b16 a[36:37], v165 offset:38912
    ds_read_b64_tr_b16 a[38:39], v165 offset:39936
    ds_read_b64_tr_b16 a[40:41], v165 offset:40960
    ds_read_b64_tr_b16 a[42:43], v165 offset:41984
    ds_read_b64_tr_b16 a[44:45], v165 offset:43008
    ds_read_b64_tr_b16 a[46:47], v165 offset:44032
    ds_read_b64_tr_b16 a[48:49], v165 offset:45056
    ds_read_b64_tr_b16 a[50:51], v165 offset:46080
    ds_read_b64_tr_b16 a[52:53], v165 offset:47104
    ds_read_b64_tr_b16 a[54:55], v165 offset:48128
    ds_read_b64_tr_b16 a[56:57], v165 offset:49152
    ds_read_b64_tr_b16 a[58:59], v165 offset:50176
    ds_read_b64_tr_b16 a[60:61], v165 offset:51200
    ds_read_b64_tr_b16 a[62:63], v165 offset:52224
    ds_read_b64_tr_b16 a[64:65], v165 offset:53248
    ds_read_b64_tr_b16 a[66:67], v165 offset:54272
    ds_read_b64_tr_b16 a[68:69], v165 offset:55296
    ds_read_b64_tr_b16 a[70:71], v165 offset:56320
    ds_read_b64_tr_b16 a[72:73], v165 offset:57344
    ds_read_b64_tr_b16 a[74:75], v165 offset:58368
    ds_read_b64_tr_b16 a[76:77], v165 offset:59392
    ds_read_b64_tr_b16 a[78:79], v165 offset:60416
    ds_read_b64_tr_b16 a[80:81], v165 offset:61440
    ds_read_b64_tr_b16 a[82:83], v165 offset:62464
    ds_read_b64_tr_b16 a[84:85], v165 offset:63488
    ds_read_b64_tr_b16 a[86:87], v165 offset:64512
    ds_read_b64_tr_b16 a[88:89], v4 offset:0
    ds_read_b64_tr_b16 a[90:91], v4 offset:1024
    ds_read_b64_tr_b16 a[92:93], v4 offset:2048
    ds_read_b64_tr_b16 a[94:95], v4 offset:3072
    ds_read_b64_tr_b16 a[96:97], v4 offset:4096
    ds_read_b64_tr_b16 a[98:99], v4 offset:5120
    ds_read_b64_tr_b16 a[100:101], v4 offset:6144
    ds_read_b64_tr_b16 a[102:103], v4 offset:7168
    ds_read_b64_tr_b16 a[104:105], v5 offset:0
    ds_read_b64_tr_b16 a[106:107], v5 offset:1024
    ds_read_b64_tr_b16 a[108:109], v5 offset:2048
    ds_read_b64_tr_b16 a[110:111], v5 offset:3072
    ds_read_b64_tr_b16 a[112:113], v5 offset:4096
    ds_read_b64_tr_b16 a[114:115], v5 offset:5120
    ds_read_b64_tr_b16 a[116:117], v5 offset:6144
    ds_read_b64_tr_b16 a[118:119], v5 offset:7168
    global_load_dword v17, v16, s[42:43] sc1
    s_waitcnt vmcnt(0) lgkmcnt(0)
    s_barrier
    s_branch G1_done
K_last:
.section .rodata,"a"
.p2align 6
.amdhsa_kernel sequential_preLN__ssm_conv_s4d__geglu_ffn__prompt_kernel
  .amdhsa_next_free_vgpr 512
  .amdhsa_next_free_sgpr 102
  .amdhsa_accum_offset 256
  .amdhsa_group_segment_fixed_size 0
  .amdhsa_kernarg_size 112
  .amdhsa_user_sgpr_count 2
  .amdhsa_user_sgpr_kernarg_segment_ptr 1
  .amdhsa_system_sgpr_workgroup_id_x 1
  .amdhsa_float_denorm_mode_32 3
.end_amdhsa_kernel
```
